```python
import torch

def _softmax(x, axis=-1):
    return torch.softmax(x, dim=axis)

def _gelu(x):
    return torch.nn.functional.gelu(x, approximate='tanh')

def _silu(x):
    return torch.nn.functional.silu(x)

def _sigmoid(x):
    return torch.sigmoid(x)

def _layernorm(x, axis=-1, eps=1e-05):
    m = x.mean(dim=axis, keepdim=True)
    v = x.var(dim=axis, keepdim=True, unbiased=False)
    return (x - m) / torch.sqrt(v + eps)

def _scatter_add(tgt, idx, src, axis=0):
    return tgt.clone().index_add_(axis, idx, src)

def _segment_sum(src, seg, n):
    out = torch.zeros((n,) + src.shape[1:], dtype=src.dtype)
    return out.index_add_(0, seg, src)

def _pad(x, pw):
    flat = tuple((v for pair in reversed(pw) for v in pair))
    return torch.nn.functional.pad(x, flat)
kernel_name = 'sequential_preLN__spectral_fnet__mixer_gmlp__prompt'

def setup_inputs():

    _w = lambda a: (lambda t: t.to(torch.bfloat16) if t.is_floating_point() else t)(torch.as_tensor(a))

    def _A_setup():
        B, S, D = (1, 2048, 640)
        ns = torch.arange(S)[:, None] * torch.arange(S)[None, :]
        nd = torch.arange(D)[:, None] * torch.arange(D)[None, :]
        Ws_re = torch.cos(-2.0 * torch.pi * ns / S).to(float)
        Ws_im = torch.sin(-2.0 * torch.pi * ns / S).to(float)
        Wd_re = torch.cos(-2.0 * torch.pi * nd / D).to(float)
        Wd_im = torch.sin(-2.0 * torch.pi * nd / D).to(float)
        return {'x': _w((lambda *s: torch.randn(*s, dtype=torch.bfloat16) * 0.05)(B, S, D)), 'dft_seq_re': _w(Ws_re), 'dft_seq_im': _w(Ws_im), 'dft_hid_re': _w(Wd_re), 'dft_hid_im': _w(Wd_im)}
    _A_in = _A_setup()

    def _B_setup():
        B, S, D, F = (1, 2048, 640, 1536)
        Fh = F // 2
        return {'x': _w((lambda *s: torch.randn(*s, dtype=torch.bfloat16) * 0.05)(B, S, D)), 'w_in': _w((lambda *s: torch.randn(*s, dtype=torch.bfloat16) * 0.8)(D, 2 * Fh)), 'w_sp': _w(0.01 * (lambda *s: torch.randn(*s, dtype=torch.bfloat16) * 0.8)(S, S)), 'b_sp': _w(1.0 + 0.01 * (lambda *s: torch.randn(*s, dtype=torch.bfloat16) * 0.8)(S)), 'w_out': _w((lambda *s: torch.randn(*s, dtype=torch.bfloat16) * 0.8)(Fh, D))}
    _B_in = _B_setup()
    return {'A_x': _A_in['x'], 'A_dft_seq_re': _A_in['dft_seq_re'], 'A_dft_seq_im': _A_in['dft_seq_im'], 'A_dft_hid_re': _A_in['dft_hid_re'], 'A_dft_hid_im': _A_in['dft_hid_im'], 'B_x': _B_in['x'], 'B_w_in': _B_in['w_in'], 'B_w_sp': _B_in['w_sp'], 'B_b_sp': _B_in['b_sp'], 'B_w_out': _B_in['w_out']}

def reference(A_x, A_dft_seq_re, A_dft_seq_im, A_dft_hid_re, A_dft_hid_im, B_x, B_w_in, B_w_sp, B_b_sp, B_w_out):

    def _A_ref(x, dft_seq_re, dft_seq_im, dft_hid_re, dft_hid_im):
        a = torch.einsum('bsd,ed->bse', x, dft_hid_re)
        b = torch.einsum('bsd,ed->bse', x, dft_hid_im)
        y = torch.einsum('ts,bse->bte', dft_seq_re, a) - torch.einsum('ts,bse->bte', dft_seq_im, b)
        return y

    def _B_ref(x, w_in, w_sp, b_sp, w_out):
        B, S, D = x.shape
        F = w_in.shape[-1]
        Fh = F // 2
        z = _gelu(torch.einsum('bsd,df->bsf', x, w_in))
        z1 = z[..., :Fh].clone()
        z2 = _layernorm(z[..., Fh:], axis=-1)
        g = torch.einsum('ts,bsf->btf', w_sp, z2) + b_sp[None, :, None]
        return torch.einsum('bsf,fd->bsd', z1 * g, w_out)
    x = A_x
    h = x + _A_ref(_layernorm(x, axis=-1), A_dft_seq_re, A_dft_seq_im, A_dft_hid_re, A_dft_hid_im)
    h2 = h + _B_ref(_layernorm(h, axis=-1), B_w_in, B_w_sp, B_b_sp, B_w_out)
    return h2
```

```asm
; @launch grid=(256,1,1) block=(256,1,1) lds=163840
.amdgcn_target "amdgcn-amd-amdhsa--gfx950"
.text
.globl sequential_preLN__spectral_fnet__mixer_gmlp__prompt_kernel
.p2align 8
.type sequential_preLN__spectral_fnet__mixer_gmlp__prompt_kernel,@function
sequential_preLN__spectral_fnet__mixer_gmlp__prompt_kernel:
    s_cmp_ge_u32 s2, 256
    s_cbranch_scc1 L_end
    s_getpc_b64 s[4:5]
L_pc0:
    v_lshlrev_b32 v8, 7, v0
    v_add_u32 v9, 0x8000, v8
    v_min_u32 v9, L_end-L_pc0, v9
    global_load_dword v247, v8, s[4:5]
    v_cmp_gt_u32 vcc, 64, v0
    s_cbranch_vccz L_ct_done
    global_load_dword v247, v9, s[4:5]
L_ct_done:
    s_load_dwordx2 s[60:61], s[0:1], 0
    s_load_dwordx4 s[64:67], s[0:1], 24
    s_load_dwordx8 s[68:75], s[0:1], 48
    s_load_dwordx4 s[76:79], s[0:1], 80
    s_load_dwordx2 s[80:81], s[0:1], 96
    v_lshrrev_b32 v1, 6, v0
    v_and_b32 v0, 63, v0
    v_readfirstlane_b32 s44, v1
    v_and_b32 v1, 15, v0
    v_lshrrev_b32 v2, 4, v0
    v_lshlrev_b32 v3, 4, v0
    s_and_b32 s52, s2, 7
    s_lshr_b32 s53, s2, 3
    s_and_b32 s54, s52, 1
    s_lshl_b32 s54, s54, 2
    s_and_b32 s55, s53, 3
    s_add_u32 s48, s54, s55
    s_lshr_b32 s54, s52, 1
    s_lshl_b32 s54, s54, 2
    s_lshr_b32 s55, s53, 3
    s_add_u32 s54, s54, s55
    s_sub_u32 s55, 32, s54
    s_cmp_eq_u32 s54, 0
    s_cselect_b32 s55, 16, s55
    s_bitcmp1_b32 s53, 2
    s_cselect_b32 s47, s55, s54
    s_mov_b32 s45, s47
    s_mov_b32 s46, s48
    s_and_b32 s50, s44, 1
    s_lshr_b32 s51, s44, 1
    s_mul_i32 s56, s44, 20480
    s_lshl_b32 s52, s44, 9
    s_add_u32 s52, s52, s45
    s_mul_i32 s52, s52, 1280
    s_mov_b32 m0, s56
    s_and_b32 s54, s46, 3
    s_mul_i32 s82, s54, 48
    s_min_u32 s82, s82, 128
    v_and_b32 v4, 7, v0
    v_xor_b32 v4, v4, v2
    v_lshrrev_b32 v5, 3, v0
    v_mul_u32_u24 v5, 40960, v5
    v_lshl_add_u32 v234, v4, 4, v5
    v_add_u32 v235, 327680, v234
    v_xor_b32 v235, 64, v235
    s_lshl_b32 s54, s50, 2
    v_and_b32 v6, 7, v0
    v_xor_b32 v6, v6, v2
    v_xor_b32 v6, s54, v6
    v_lshlrev_b32 v6, 4, v6
    v_lshrrev_b32 v7, 3, v0
    v_mul_u32_u24 v4, 2560, v7
    v_add_u32 v236, v6, v4
    v_cmp_gt_u32 vcc, 8, v0
    s_or_b32 s54, s46, s50
    s_cmp_eq_u32 s54, 0
    s_cselect_b32 s54, 409600, 0
    v_mov_b32 v4, s54
    v_cndmask_b32 v4, 0, v4, vcc
    v_add_u32 v237, v236, v4
    s_lshl_b32 s54, s82, 1
    s_lshr_b32 s55, s46, 2
    s_add_u32 s83, s54, s55
    s_lshl_b32 s55, s50, 4
    s_add_u32 s54, s83, s55
    s_mul_i32 s54, s54, 1280
    s_mul_i32 s55, s51, 6
    s_add_u32 s55, s55, s50
    s_mul_i32 s55, s55, 5120
    s_add_u32 s55, s55, 81920
    s_movk_i32 s84, 0x199a
    v_mul_u32_u24 v4, s84, v0
    v_lshrrev_b32 v4, 16, v4
    v_mul_u32_u24 v5, 10, v4
    v_sub_u32 v5, v0, v5
    v_mul_u32_u24 v4, 40960, v4
    v_lshl_add_u32 v4, v5, 7, v4
    s_and_b32 s84, s46, 3
    s_lshl_b32 s84, s84, 2
    s_add_u32 s84, s84, s44
    s_mul_i32 s84, s84, 163840
    s_mul_i32 s85, s45, 1280
    s_add_u32 s84, s84, s85
    s_movk_i32 s85, 0x3334
    v_mul_u32_u24 v5, s85, v0
    v_lshrrev_b32 v5, 16, v5
    v_mul_u32_u24 v6, 5, v5
    v_sub_u32 v6, v0, v6
    v_mul_u32_u24 v5, 2560, v5
    v_lshl_add_u32 v5, v6, 7, v5
    s_lshr_b32 s85, s2, 5
    s_lshl_b32 s85, s85, 1
    s_add_u32 s85, s85, s50
    s_mul_i32 s85, s85, 6
    s_add_u32 s85, s85, s83
    s_mul_i32 s85, s85, 1280
    s_waitcnt lgkmcnt(0)
    s_mov_b32 s8, s60
    s_mov_b32 s9, s61
    s_mov_b32 s10, 0x280000
    s_mov_b32 s11, 0x20000
    s_cmp_eq_u32 s51, 0
    s_cselect_b32 s12, s64, s66
    s_cselect_b32 s13, s65, s67
    s_mov_b32 s14, 0xc8000
    s_mov_b32 s15, 0x20000
    s_mov_b64 exec, 0x7fff
    buffer_load_dword v247, v5, s[12:15], s85 offen
    s_mov_b32 exec_lo, -1
    s_mov_b32 exec_hi, 0xff
    buffer_load_dword v247, v4, s[8:11], s84 offen
    s_mov_b64 exec, -1
    buffer_load_dwordx4 v234, s[8:11], s52 offen lds
    s_add_u32 m0, m0, 1024
    s_nop 0
    buffer_load_dwordx4 v235, s[8:11], s52 offen lds
    s_add_u32 m0, m0, 1024
    s_add_u32 s52, s52, 640
    buffer_load_dwordx4 v234, s[8:11], s52 offen lds
    s_add_u32 m0, m0, 1024
    s_nop 0
    buffer_load_dwordx4 v235, s[8:11], s52 offen lds
    s_add_u32 m0, m0, 1024
    s_sub_u32 s52, s52, 512
    s_mov_b32 s16, s68
    s_mov_b32 s17, s69
    s_mov_b32 s18, 0x1e0000
    s_mov_b32 s19, 0x20000
    s_mov_b32 s20, s70
    s_mov_b32 s21, s71
    s_mov_b32 s22, 0x800000
    s_mov_b32 s23, 0x20000
    s_mov_b32 s40, s72
    s_mov_b32 s41, s73
    s_mov_b32 s42, 0x1000
    s_mov_b32 s43, 0x20000
    s_mov_b32 s24, s74
    s_mov_b32 s25, s75
    s_mov_b32 s26, 0xf0000
    s_mov_b32 s27, 0x20000
    s_mov_b32 s28, s76
    s_mov_b32 s29, s77
    s_mov_b32 s30, 0x280000
    s_mov_b32 s31, 0x20000
    s_mov_b32 s36, s78
    s_mov_b32 s37, s79
    s_mov_b32 s38, 0x100
    s_mov_b32 s39, 0x20000
    s_mov_b32 s32, s80
    s_mov_b32 s33, s81
    s_mov_b32 s34, 0x4000000
    s_mov_b32 s35, 0x20000
    v_lshrrev_b32 v4, 1, v1
    v_xor_b32 v4, v4, v2
    v_lshlrev_b32 v4, 4, v4
    v_and_b32 v5, 7, v1
    v_lshlrev_b32 v5, 7, v5
    v_lshrrev_b32 v6, 3, v1
    v_mul_u32_u24 v6, 5120, v6
    v_add3_u32 v5, v5, v6, v4
    v_and_b32 v6, 7, v1
    v_lshl_add_u32 v6, v6, 7, v4
    v_lshrrev_b32 v7, 3, v1
    v_lshl_add_u32 v6, v7, 10, v6
    v_add_u32 v14, s56, v6
    v_xor_b32 v15, 64, v14
    v_add_u32 v16, 0x14000, v5
    v_xor_b32 v17, 64, v16
    v_lshl_add_u32 v5, v1, 7, v4
    v_add_u32 v232, 0x23000, v5
    v_xor_b32 v233, 64, v232
    s_lshl_b32 s84, s44, 1
    v_lshrrev_b32 v4, 1, v2
    v_or_b32 v4, s84, v4
    v_lshrrev_b32 v5, 1, v1
    v_xor_b32 v4, v4, v5
    v_lshlrev_b32 v4, 4, v4
    v_and_b32 v5, 1, v2
    v_lshl_add_u32 v4, v5, 3, v4
    v_lshl_add_u32 v4, v1, 7, v4
    v_add_u32 v18, 0x23000, v4
    v_mov_b32 v20, 0x3f803f80
    v_mov_b32 v21, 0x3f803f80
    v_mov_b32 v22, 0x3f803f80
    v_mov_b32 v23, 0x3f803f80
    s_cmp_lt_u32 s46, 4
    s_cselect_b32 s96, 1.0, -1.0
    s_cselect_b32 s59, 0xbb4ccccd, 0
    s_mov_b32 s97, s96
    s_mov_b32 s58, 0xffff0000
    s_lshl_b32 s84, s44, 4
    v_add_u32 v4, s84, v1
    v_lshlrev_b32 v5, 8, v2
    v_add_u32 v5, s45, v5
    v_mul_u32_u24 v5, v4, v5
    v_cvt_f32_u32 v5, v5
    v_cvt_f32_u32 v4, v4
    v_mul_f32 v5, 0x3a000000, v5
    v_mul_f32 v4, 0x3c800000, v4
    v_fract_f32 v32, v5
    v_fmamk_f32 v33, v4, 0x3f800000, v5
    v_fract_f32 v33, v33
    v_cos_f32 v34, v32
    v_cos_f32 v35, v33
    v_sin_f32 v36, v32
    v_sin_f32 v37, v33
    v_cvt_pk_bf16_f32 v192, v34, v35
    v_cvt_pk_bf16_f32 v200, -v36, -v37
    v_cvt_pk_bf16_f32 v208, v36, v37
    v_fmamk_f32 v32, v4, 0x40000000, v5
    v_fract_f32 v32, v32
    v_fmamk_f32 v33, v4, 0x40400000, v5
    v_fract_f32 v33, v33
    v_cos_f32 v34, v32
    v_cos_f32 v35, v33
    v_sin_f32 v36, v32
    v_sin_f32 v37, v33
    v_cvt_pk_bf16_f32 v193, v34, v35
    v_cvt_pk_bf16_f32 v201, -v36, -v37
    v_cvt_pk_bf16_f32 v209, v36, v37
    v_fmamk_f32 v32, v4, 0x40800000, v5
    v_fract_f32 v32, v32
    v_fmamk_f32 v33, v4, 0x40a00000, v5
    v_fract_f32 v33, v33
    v_cos_f32 v34, v32
    v_cos_f32 v35, v33
    v_sin_f32 v36, v32
    v_sin_f32 v37, v33
    v_cvt_pk_bf16_f32 v194, v34, v35
    v_cvt_pk_bf16_f32 v202, -v36, -v37
    v_cvt_pk_bf16_f32 v210, v36, v37
    v_fmamk_f32 v32, v4, 0x40c00000, v5
    v_fract_f32 v32, v32
    v_fmamk_f32 v33, v4, 0x40e00000, v5
    v_fract_f32 v33, v33
    v_cos_f32 v34, v32
    v_cos_f32 v35, v33
    v_sin_f32 v36, v32
    v_sin_f32 v37, v33
    v_cvt_pk_bf16_f32 v195, v34, v35
    v_cvt_pk_bf16_f32 v203, -v36, -v37
    v_cvt_pk_bf16_f32 v211, v36, v37
    s_mov_b32 s84, 0x80008000
    v_and_b32 v4, 1, v1
    v_mul_lo_u32 v4, v4, s84
    v_xor_b32 v196, v4, v192
    v_xor_b32 v197, v4, v193
    v_xor_b32 v198, v4, v194
    v_xor_b32 v199, v4, v195
    v_xor_b32 v204, v4, v200
    v_xor_b32 v205, v4, v201
    v_xor_b32 v206, v4, v202
    v_xor_b32 v207, v4, v203
    v_xor_b32 v212, v4, v208
    v_xor_b32 v213, v4, v209
    v_xor_b32 v214, v4, v210
    v_xor_b32 v215, v4, v211
    s_cmp_lg_u32 s47, 0
    s_cselect_b32 s57, s51, 0
    s_mul_i32 s85, s57, 31
    v_lshlrev_b32 v6, 2, v2
    v_cvt_f32_u32 v6, v6
    v_xor_b32 v7, s85, v1
    v_cvt_f32_u32 v4, v7
    v_mul_f32 v4, 0x3d000000, v4
    v_mul_f32 v5, v4, v6
    v_fract_f32 v32, v5
    v_fmamk_f32 v33, v4, 0x3f800000, v5
    v_fract_f32 v33, v33
    v_cos_f32 v34, v32
    v_cos_f32 v35, v33
    v_sin_f32 v36, v32
    v_sin_f32 v37, v33
    v_cvt_pk_bf16_f32 v216, v34, v35
    v_cvt_pk_bf16_f32 v218, v36, v37
    v_fmamk_f32 v32, v4, 0x40000000, v5
    v_fract_f32 v32, v32
    v_fmamk_f32 v33, v4, 0x40400000, v5
    v_fract_f32 v33, v33
    v_cos_f32 v34, v32
    v_cos_f32 v35, v33
    v_sin_f32 v36, v32
    v_sin_f32 v37, v33
    v_cvt_pk_bf16_f32 v217, v34, v35
    v_cvt_pk_bf16_f32 v219, v36, v37
    v_and_b32 v7, 1, v7
    v_mul_lo_u32 v7, v7, s84
    s_brev_b32 s85, 1
    v_xor_b32 v220, v7, v216
    v_xor_b32 v221, v7, v217
    v_xor_b32 v222, v7, v218
    v_xor_b32 v223, v7, v219
    v_xor_b32 v224, s85, v216
    v_xor_b32 v225, s85, v217
    v_xor_b32 v226, s85, v218
    v_xor_b32 v227, s85, v219
    v_xor_b32 v228, s85, v220
    v_xor_b32 v229, s85, v221
    v_xor_b32 v230, s85, v222
    v_xor_b32 v231, s85, v223
    s_lshl_b32 s84, s51, 5
    s_cmp_eq_u32 s47, 0
    s_cselect_b32 s84, s84, s47
    s_sub_u32 s85, 2048, s47
    s_cmp_eq_u32 s57, 1
    s_cselect_b32 s88, s85, s84
    s_cselect_b32 s89, -64, 64
    v_lshrrev_b32 v4, 2, v0
    v_and_b32 v5, 3, v0
    v_lshlrev_b32 v5, 4, v5
    s_movk_i32 s84, 1280
    v_add_u32 v6, 0, v4
    v_mul_i32_i24 v6, s89, v6
    v_add_u32 v6, s88, v6
    v_mad_u32_u24 v9, v6, s84, v5
    v_sub_u32 v6, 2048, v6
    v_and_b32 v6, 2047, v6
    v_mad_u32_u24 v11, v6, s84, v5
    v_add_u32 v6, 16, v4
    v_mul_i32_i24 v6, s89, v6
    v_add_u32 v6, s88, v6
    v_mad_u32_u24 v10, v6, s84, v5
    v_sub_u32 v6, 2048, v6
    v_and_b32 v6, 2047, v6
    v_mad_u32_u24 v12, v6, s84, v5
    s_lshl_b32 s85, s50, 4
    v_add_u32 v6, s85, v1
    v_mul_i32_i24 v6, s89, v6
    v_add_u32 v13, s88, v6
    s_mul_i32 s85, s51, 192
    s_mul_i32 s84, s50, 31
    s_movk_i32 s86, 0x1556
    s_movk_i32 s87, 3072
    v_add_u32 v4, 0, v0
    v_add_u32 v4, s85, v4
    v_mul_u32_u24 v5, s86, v4
    v_lshrrev_b32 v5, 16, v5
    v_mul_u32_u24 v6, 12, v5
    v_sub_u32 v4, v4, v6
    v_lshrrev_b32 v6, 2, v5
    v_and_b32 v6, 2, v6
    v_xor_b32 v4, v4, v6
    v_lshlrev_b32 v4, 4, v4
    v_xor_b32 v5, s84, v5
    v_mad_u32_u24 v238, v5, s87, v4
    v_mov_b32 v7, v4
    v_add_u32 v4, 64, v0
    v_add_u32 v4, s85, v4
    v_mul_u32_u24 v5, s86, v4
    v_lshrrev_b32 v5, 16, v5
    v_mul_u32_u24 v6, 12, v5
    v_sub_u32 v4, v4, v6
    v_lshrrev_b32 v6, 2, v5
    v_and_b32 v6, 2, v6
    v_xor_b32 v4, v4, v6
    v_lshlrev_b32 v4, 4, v4
    v_xor_b32 v5, s84, v5
    v_mad_u32_u24 v239, v5, s87, v4
    v_add_u32 v4, 128, v0
    v_add_u32 v4, s85, v4
    v_mul_u32_u24 v5, s86, v4
    v_lshrrev_b32 v5, 16, v5
    v_mul_u32_u24 v6, 12, v5
    v_sub_u32 v4, v4, v6
    v_lshrrev_b32 v6, 2, v5
    v_and_b32 v6, 2, v6
    v_xor_b32 v4, v4, v6
    v_lshlrev_b32 v4, 4, v4
    v_xor_b32 v5, s84, v5
    v_mad_u32_u24 v240, v5, s87, v4
    s_mul_i32 s91, s50, 1870848
    s_mul_i32 s92, s50, -196608
    s_add_u32 s92, s92, 98304
    s_cmp_eq_u32 s50, 0
    s_cselect_b32 s84, 983040, 0
    s_cmp_eq_u32 s51, 0
    s_cselect_b32 s85, 12, 0
    v_cmp_gt_u32 vcc, s85, v0
    v_add_u32 v7, s84, v7
    v_add_u32 v241, s91, v238
    v_cndmask_b32 v241, v241, v7, vcc
    s_mul_i32 s90, s48, 192
    s_add_u32 s90, s90, 1536
    s_or_b32 s84, s2, s44
    s_cmp_lg_u32 s84, 0
    s_cbranch_scc1 L_nonce_skip
    s_memrealtime s[84:85]
    s_waitcnt lgkmcnt(0)
    s_or_b32 s84, s84, 1
    v_mov_b32 v4, s84
    v_mov_b32 v5, 0
    global_store_dword v5, v4, s[78:79] sc1
L_nonce_skip:
    s_mul_i32 s60, s50, 576
    s_sub_u32 s61, 1216, s60
    s_lshl_b32 s73, s50, 12
    s_add_u32 s73, s73, s56
    s_mul_i32 s74, s50, -2048
    s_add_u32 s74, s74, 1024
    s_ashr_i32 s75, s74, 4
    s_mul_i32 s62, s50, 30720
    s_mul_i32 s84, s51, 3072
    s_add_u32 s62, s62, s84
    s_movk_i32 s84, 0x2aab
    v_mul_u32_u24 v4, s84, v0
    v_lshrrev_b32 v4, 16, v4
    v_mul_u32_u24 v5, 6, v4
    v_sub_u32 v5, v0, v5
    v_mul_u32_u24 v4, 3072, v4
    v_lshl_add_u32 v250, v5, 7, v4
    v_mov_b32 v252, 0
    s_and_b32 s85, s48, 4
    s_mul_i32 s85, s85, 192
    s_lshr_b32 s71, s2, 3
    s_lshl_b32 s71, s71, 2
    s_add_u32 s71, s71, s44
    s_mul_i32 s71, s71, 15360
    s_add_u32 s71, s71, s85
    s_lshr_b32 s69, s2, 5
    s_lshl_b32 s69, s69, 1
    s_and_b32 s84, s46, 1
    s_add_u32 s69, s69, s84
    s_lshl_b32 s69, s69, 2
    s_add_u32 s69, s69, s44
    s_mul_i32 s69, s69, 30720
    s_add_u32 s69, s69, s85
    s_add_u32 s69, s69, 1536
    v_lshrrev_b32 v4, 2, v1
    v_lshl_add_u32 v4, v2, 3, v4
    v_mul_u32_u24 v4, 192, v4
    v_and_b32 v5, 3, v1
    v_lshl_add_u32 v4, v5, 3, v4
    s_mul_i32 s84, s50, 30720
    s_mul_i32 s85, s51, 96
    s_add_u32 s84, s84, s85
    v_add_u32 v4, s84, v4
    v_and_b32 v5, 1, v2
    v_lshlrev_b32 v5, 5, v5
    s_lshl_b32 s84, s51, 1
    s_sub_u32 s84, 1, s84
    v_mul_i32_i24 v5, s84, v5
    v_add_u32 v40, v4, v5
    v_sub_u32 v41, v4, v5
    v_add_u32 v42, 0x14000, v40
    v_add_u32 v43, 0x14000, v41
    v_cmp_gt_u32 s[86:87], 16, v0
    v_lshlrev_b32 v4, 6, v1
    v_add_u32 v4, s56, v4
    v_lshlrev_b32 v5, 4, v2
    v_add_u32 v44, v4, v5
    v_sub_u32 v4, v4, v5
    v_add_u32 v45, 10288, v4
    v_add_u32 v5, 10304, v4
    v_add_u32 v4, 9216, v4
    v_cndmask_b32 v46, v5, v4, s[86:87]
    s_cmp_eq_u32 s50, 0
    s_cselect_b64 s[94:95], s[86:87], 0
    v_lshrrev_b32 v4, 3, v0
    v_mul_u32_u24 v4, 1280, v4
    v_and_b32 v5, 1, v2
    v_lshlrev_b32 v5, 2, v5
    v_xor_b32 v5, v5, v0
    v_and_b32 v5, 7, v5
    v_lshl_add_u32 v47, v5, 4, v4
    v_lshrrev_b32 v4, 2, v0
    v_lshlrev_b32 v4, 7, v4
    v_and_b32 v5, 8, v0
    v_lshl_add_u32 v4, v5, 3, v4
    v_and_b32 v5, 3, v0
    v_lshl_add_u32 v4, v5, 4, v4
    v_and_b32 v5, 1, v2
    v_lshl_add_u32 v4, v5, 3, v4
    v_add_u32 v4, 0x14000, v4
    v_add_u32 v48, s56, v4
    v_xor_b32 v49, 8, v48
    v_xor_b32 v50, 64, v48
    v_xor_b32 v51, 64, v49
    s_mul_i32 s4, s51, 40960
    s_mul_i32 s5, s50, 5120
    s_add_u32 s4, s4, s5
    s_add_u32 s4, s4, 0x0
    v_add_u32 v52, s4, v3
    s_add_u32 s5, s5, 10240
    s_cmp_eq_u32 s47, 0
    s_cbranch_scc1 L_hm_rb0
    s_xor_b32 s4, s51, 1
    s_mul_i32 s4, s4, 40960
    s_add_u32 s4, s4, s5
    v_add_u32 v53, s4, v3
    v_add_u32 v54, 20480, v53
    s_xor_b32 s4, s44, 2
    v_mov_b32 v6, s4
    v_mov_b32 v7, v1
    s_branch L_hm_done
L_hm_rb0:
    s_mul_i32 s4, s51, 40960
    s_add_u32 s4, s4, s5
    s_sub_u32 s5, 32, s51
    v_add_u32 v4, 0, v1
    v_sub_u32 v4, s5, v4
    v_and_b32 v4, 31, v4
    v_lshrrev_b32 v5, 4, v4
    v_mul_u32_u24 v5, 20480, v5
    v_and_b32 v4, 15, v4
    v_lshl_add_u32 v4, v2, 4, v4
    v_lshl_add_u32 v4, v4, 4, v5
    v_add_u32 v53, s4, v4
    v_add_u32 v4, 16, v1
    v_sub_u32 v4, s5, v4
    v_and_b32 v4, 31, v4
    v_lshrrev_b32 v5, 4, v4
    v_mul_u32_u24 v5, 20480, v5
    v_and_b32 v4, 15, v4
    v_lshl_add_u32 v4, v2, 4, v4
    v_lshl_add_u32 v4, v4, 4, v5
    v_add_u32 v54, s4, v4
    s_lshl_b32 s4, s50, 4
    s_sub_u32 s5, s5, s4
    v_sub_u32 v4, s5, v1
    v_and_b32 v4, 31, v4
    v_and_b32 v7, 15, v4
    v_lshrrev_b32 v6, 4, v4
    s_lshl_b32 s4, s51, 1
    v_add_u32 v6, s4, v6
L_hm_done:
    s_mul_i32 s4, s51, 40960
    s_lshl_b32 s5, s50, 10
    s_add_u32 s5, s5, s4
    v_lshrrev_b32 v4, 2, v1
    v_lshl_add_u32 v4, v4, 4, v1
    v_lshlrev_b32 v4, 4, v4
    v_and_b32 v5, 3, v1
    v_lshl_add_u32 v4, v5, 2, v4
    v_add_u32 v55, s5, v4
    s_lshl_b32 s5, s50, 8
    s_add_u32 s5, s5, s4
    v_lshlrev_b32 v4, 2, v1
    v_add_u32 v57, s5, v4
    v_lshrrev_b32 v4, 2, v7
    v_lshl_add_u32 v4, v4, 4, v7
    v_lshlrev_b32 v4, 4, v4
    v_and_b32 v5, 3, v7
    v_lshl_add_u32 v4, v5, 2, v4
    v_lshrrev_b32 v5, 1, v6
    v_mul_u32_u24 v5, 40960, v5
    v_and_b32 v6, 1, v6
    v_lshl_add_u32 v4, v6, 10, v4
    v_add_u32 v56, v4, v5
    v_lshl_add_u32 v5, v6, 8, v5
    v_lshl_add_u32 v58, v7, 2, v5
    v_add_u32 v55, 0x14000, v55
    v_add_u32 v56, 0x14000, v56
    v_add_u32 v57, 0x14000, v57
    v_add_u32 v58, 0x14000, v58
    s_xor_b32 s4, s44, 0
    s_mul_i32 s5, s4, 20480
    s_mul_i32 s84, s50, 10240
    s_add_u32 s5, s5, s84
    s_add_u32 s5, s5, 0x0
    v_add_u32 v59, s5, v3
    s_and_b32 s85, s4, 1
    s_mul_i32 s85, s85, 9216
    s_lshr_b32 s84, s4, 1
    s_mul_i32 s84, s84, 81920
    s_add_u32 s84, s84, s85
    s_add_u32 s84, s84, 61440
    v_add_u32 v63, s84, v3
    s_xor_b32 s4, s44, 1
    s_mul_i32 s5, s4, 20480
    s_mul_i32 s84, s50, 10240
    s_add_u32 s5, s5, s84
    s_add_u32 s5, s5, 0x0
    v_add_u32 v60, s5, v3
    s_and_b32 s85, s4, 1
    s_mul_i32 s85, s85, 9216
    s_lshr_b32 s84, s4, 1
    s_mul_i32 s84, s84, 81920
    s_add_u32 s84, s84, s85
    s_add_u32 s84, s84, 61440
    v_add_u32 v64, s84, v3
    s_xor_b32 s4, s44, 2
    s_mul_i32 s5, s4, 20480
    s_mul_i32 s84, s50, 10240
    s_add_u32 s5, s5, s84
    s_add_u32 s5, s5, 0x0
    v_add_u32 v61, s5, v3
    s_and_b32 s85, s4, 1
    s_mul_i32 s85, s85, 9216
    s_lshr_b32 s84, s4, 1
    s_mul_i32 s84, s84, 81920
    s_add_u32 s84, s84, s85
    s_add_u32 s84, s84, 64512
    v_add_u32 v65, s84, v3
    s_xor_b32 s4, s44, 3
    s_mul_i32 s5, s4, 20480
    s_mul_i32 s84, s50, 10240
    s_add_u32 s5, s5, s84
    s_add_u32 s5, s5, 0x0
    v_add_u32 v62, s5, v3
    s_and_b32 s85, s4, 1
    s_mul_i32 s85, s85, 9216
    s_lshr_b32 s84, s4, 1
    s_mul_i32 s84, s84, 81920
    s_add_u32 s84, s84, s85
    s_add_u32 s84, s84, 67584
    v_add_u32 v66, s84, v3
    s_mul_i32 s4, s44, 20480
    s_add_u32 s4, s4, 0x0
    v_lshlrev_b32 v7, 4, v1
    v_add_u32 v7, s4, v7
    s_cmp_ge_u32 s48, 4
    s_cbranch_scc1 L_hr_m
    s_mul_i32 s4, s48, 2560
    v_lshlrev_b32 v5, 8, v2
    v_add3_u32 v67, v5, v7, s4
    v_add_u32 v68, 1024, v67
    v_lshrrev_b32 v5, 1, v2
    v_lshlrev_b32 v5, 8, v5
    v_and_b32 v4, 1, v2
    v_lshl_add_u32 v5, v4, 3, v5
    s_add_u32 s4, s4, 2048
    v_add3_u32 v69, v5, v7, s4
    v_add_u32 v70, 10240, v7
    v_mov_b32 v71, v7
    v_mov_b32 v72, v7
    s_branch L_hr_done
L_hr_m:
    s_mul_i32 s4, s48, 10
    s_sub_u32 s4, 115, s4
    v_sub_u32 v4, s4, v2
    v_lshl_add_u32 v68, v4, 8, v7
    v_add_u32 v67, 1024, v68
    v_cmp_eq_u32 vcc, 75, v4
    v_add_u32 v71, 256, v68
    v_add_u32 v5, 1280, v68
    v_cndmask_b32 v70, v5, v7, vcc
    s_mul_i32 s4, s48, 80
    s_sub_u32 s4, 892, s4
    v_lshlrev_b32 v4, 2, v2
    v_sub_u32 v4, s4, v4
    v_lshrrev_b32 v5, 3, v4
    v_lshlrev_b32 v5, 8, v5
    v_and_b32 v6, 4, v4
    v_lshl_add_u32 v5, v6, 1, v5
    v_add_u32 v69, v5, v7
    v_add_u32 v4, 4, v4
    v_lshrrev_b32 v5, 3, v4
    v_lshlrev_b32 v5, 8, v5
    v_and_b32 v6, 4, v4
    v_lshl_add_u32 v5, v6, 1, v5
    v_add_u32 v72, v5, v7
    v_add_u32 v4, 4, v4
L_hr_done:
    s_and_b32 s66, s88, 63
    s_mul_i32 s66, s66, 40960
    s_mul_i32 s5, s50, 640
    s_add_u32 s66, s66, s5
    v_and_b32 v4, 7, v0
    v_xor_b32 v4, v4, v2
    v_lshlrev_b32 v4, 4, v4
    v_lshrrev_b32 v5, 3, v0
    s_cmp_eq_u32 s47, 0
    s_cselect_b64 vcc, -1, 0
    s_xor_b32 s4, s50, 0
    s_lshl_b32 s4, s4, 4
    s_add_u32 s4, s4, 0
    v_add_u32 v6, s4, v5
    v_mul_i32_i24 v6, s89, v6
    v_add_u32 v6, s88, v6
    v_lshl_add_u32 v73, v6, 12, v4
    v_sub_u32 v7, 2048, v6
    v_xor_b32 v6, 32, v6
    v_cndmask_b32 v6, v7, v6, vcc
    v_lshl_add_u32 v77, v6, 12, v4
    v_xor_b32 v4, 64, v4
    s_xor_b32 s4, s50, 0
    s_lshl_b32 s4, s4, 4
    s_add_u32 s4, s4, 8
    v_add_u32 v6, s4, v5
    v_mul_i32_i24 v6, s89, v6
    v_add_u32 v6, s88, v6
    v_lshl_add_u32 v74, v6, 12, v4
    v_sub_u32 v7, 2048, v6
    v_xor_b32 v6, 32, v6
    v_cndmask_b32 v6, v7, v6, vcc
    v_lshl_add_u32 v78, v6, 12, v4
    v_xor_b32 v4, 64, v4
    s_xor_b32 s4, s50, 1
    s_lshl_b32 s4, s4, 4
    s_add_u32 s4, s4, 0
    v_add_u32 v6, s4, v5
    v_mul_i32_i24 v6, s89, v6
    v_add_u32 v6, s88, v6
    v_lshl_add_u32 v75, v6, 12, v4
    v_sub_u32 v7, 2048, v6
    v_xor_b32 v6, 32, v6
    v_cndmask_b32 v6, v7, v6, vcc
    v_lshl_add_u32 v79, v6, 12, v4
    v_xor_b32 v4, 64, v4
    s_xor_b32 s4, s50, 1
    s_lshl_b32 s4, s4, 4
    s_add_u32 s4, s4, 8
    v_add_u32 v6, s4, v5
    v_mul_i32_i24 v6, s89, v6
    v_add_u32 v6, s88, v6
    v_lshl_add_u32 v76, v6, 12, v4
    v_sub_u32 v7, 2048, v6
    v_xor_b32 v6, 32, v6
    v_cndmask_b32 v6, v7, v6, vcc
    v_lshl_add_u32 v80, v6, 12, v4
    v_xor_b32 v4, 64, v4
    v_lshrrev_b32 v4, 1, v1
    v_xor_b32 v4, v4, v2
    v_lshlrev_b32 v4, 4, v4
    v_and_b32 v6, 7, v1
    v_lshl_add_u32 v4, v6, 7, v4
    v_lshrrev_b32 v6, 3, v1
    v_lshl_add_u32 v4, v6, 10, v4
    s_mul_i32 s67, s44, 15360
    v_add_u32 v81, s67, v4
    v_xor_b32 v82, 64, v81
    s_lshl_b32 s68, s44, 10
    s_mul_i32 s76, s50, 9216
    s_mul_i32 s4, s51, 81920
    s_add_u32 s76, s76, s4
    s_add_u32 s76, s76, 61440
    v_add_u32 v83, s76, v4
    v_xor_b32 v84, 64, v83
    v_accvgpr_write_b32 a196, v40
    v_accvgpr_write_b32 a197, v41
    v_accvgpr_write_b32 a198, v42
    v_accvgpr_write_b32 a199, v43
    v_accvgpr_write_b32 a200, v44
    v_accvgpr_write_b32 a201, v45
    v_accvgpr_write_b32 a202, v46
    v_accvgpr_write_b32 a203, v47
    v_accvgpr_write_b32 a204, v48
    v_accvgpr_write_b32 a205, v49
    v_accvgpr_write_b32 a206, v50
    v_accvgpr_write_b32 a207, v51
    v_accvgpr_write_b32 a208, v52
    v_accvgpr_write_b32 a209, v53
    v_accvgpr_write_b32 a210, v54
    v_accvgpr_write_b32 a211, v55
    v_accvgpr_write_b32 a212, v56
    v_accvgpr_write_b32 a213, v57
    v_accvgpr_write_b32 a214, v58
    v_accvgpr_write_b32 a215, v59
    v_accvgpr_write_b32 a216, v60
    v_accvgpr_write_b32 a217, v61
    v_accvgpr_write_b32 a218, v62
    v_accvgpr_write_b32 a219, v63
    v_accvgpr_write_b32 a220, v64
    v_accvgpr_write_b32 a221, v65
    v_accvgpr_write_b32 a222, v66
    v_accvgpr_write_b32 a223, v67
    v_accvgpr_write_b32 a224, v68
    v_accvgpr_write_b32 a225, v69
    v_accvgpr_write_b32 a226, v70
    v_accvgpr_write_b32 a227, v71
    v_accvgpr_write_b32 a228, v72
    v_accvgpr_write_b32 a229, v73
    v_accvgpr_write_b32 a230, v74
    v_accvgpr_write_b32 a231, v75
    v_accvgpr_write_b32 a232, v76
    v_accvgpr_write_b32 a233, v77
    v_accvgpr_write_b32 a234, v78
    v_accvgpr_write_b32 a235, v79
    v_accvgpr_write_b32 a236, v80
    v_accvgpr_write_b32 a237, v81
    v_accvgpr_write_b32 a238, v82
    v_accvgpr_write_b32 a239, v83
    v_accvgpr_write_b32 a240, v84
    buffer_load_dwordx4 v234, s[8:11], s52 offen lds
    s_add_u32 m0, m0, 1024
    s_nop 0
    buffer_load_dwordx4 v235, s[8:11], s52 offen lds
    s_add_u32 m0, m0, 1024
    s_add_u32 s52, s52, 640
    buffer_load_dwordx4 v234, s[8:11], s52 offen lds
    s_add_u32 m0, m0, 1024
    s_nop 0
    buffer_load_dwordx4 v235, s[8:11], s52 offen lds
    s_add_u32 m0, m0, 1024
    s_sub_u32 s52, s52, 512
    s_waitcnt vmcnt(6)
    ds_read_b128 v[32:35], v14 offset:0
    ds_read_b128 v[36:39], v15 offset:0
    buffer_load_dwordx4 v234, s[8:11], s52 offen lds
    s_add_u32 m0, m0, 1024
    s_nop 0
    buffer_load_dwordx4 v235, s[8:11], s52 offen lds
    s_add_u32 m0, m0, 1024
    s_add_u32 s52, s52, 640
    s_waitcnt vmcnt(6)
    ds_read_b128 v[72:75], v14 offset:2048
    ds_read_b128 v[76:79], v15 offset:2048
    buffer_load_dwordx4 v234, s[8:11], s52 offen lds
    s_add_u32 m0, m0, 1024
    s_nop 0
    s_waitcnt lgkmcnt(2)
    v_mfma_f32_16x16x32_bf16 v[24:27], v[20:23], v[32:35], 0
    v_lshlrev_b32 v112, 16, v32
    v_lshlrev_b32 v113, 16, v33
    v_mfma_f32_16x16x32_bf16 v[28:31], v[32:35], v[32:35], 0
    v_lshlrev_b32 v114, 16, v34
    v_lshlrev_b32 v115, 16, v35
    v_and_b32 v32, s58, v32
    v_and_b32 v33, s58, v33
    v_and_b32 v34, s58, v34
    v_and_b32 v35, s58, v35
    buffer_load_dwordx4 v235, s[8:11], s52 offen lds
    s_add_u32 m0, m0, 1024
    s_sub_u32 s52, s52, 512
    v_mfma_f32_16x16x32_bf16 v[24:27], v[20:23], v[36:39], v[24:27]
    v_lshlrev_b32 v116, 16, v36
    v_lshlrev_b32 v117, 16, v37
    v_mfma_f32_16x16x32_bf16 v[28:31], v[36:39], v[36:39], v[28:31]
    v_lshlrev_b32 v118, 16, v38
    v_lshlrev_b32 v119, 16, v39
    v_and_b32 v36, s58, v36
    v_and_b32 v37, s58, v37
    v_and_b32 v38, s58, v38
    v_and_b32 v39, s58, v39
    s_waitcnt vmcnt(6)
    ds_read_b128 v[40:43], v14 offset:4096
    ds_read_b128 v[44:47], v15 offset:4096
    buffer_load_dwordx4 v234, s[8:11], s52 offen lds
    s_add_u32 m0, m0, 1024
    s_nop 0
    s_waitcnt lgkmcnt(2)
    v_mfma_f32_16x16x32_bf16 v[24:27], v[20:23], v[72:75], v[24:27]
    v_lshlrev_b32 v152, 16, v72
    v_lshlrev_b32 v153, 16, v73
    v_mfma_f32_16x16x32_bf16 v[28:31], v[72:75], v[72:75], v[28:31]
    v_lshlrev_b32 v154, 16, v74
    v_lshlrev_b32 v155, 16, v75
    v_and_b32 v72, s58, v72
    v_and_b32 v73, s58, v73
    v_and_b32 v74, s58, v74
    v_and_b32 v75, s58, v75
    buffer_load_dwordx4 v235, s[8:11], s52 offen lds
    s_add_u32 m0, m0, 1024
    s_add_u32 s52, s52, 640
    v_mfma_f32_16x16x32_bf16 v[24:27], v[20:23], v[76:79], v[24:27]
    v_lshlrev_b32 v156, 16, v76
    v_lshlrev_b32 v157, 16, v77
    v_mfma_f32_16x16x32_bf16 v[28:31], v[76:79], v[76:79], v[28:31]
    v_lshlrev_b32 v158, 16, v78
    v_lshlrev_b32 v159, 16, v79
    v_and_b32 v76, s58, v76
    v_and_b32 v77, s58, v77
    v_and_b32 v78, s58, v78
    v_and_b32 v79, s58, v79
    s_waitcnt vmcnt(6)
    ds_read_b128 v[80:83], v14 offset:6144
    ds_read_b128 v[84:87], v15 offset:6144
    buffer_load_dwordx4 v234, s[8:11], s52 offen lds
    s_add_u32 m0, m0, 1024
    s_nop 0
    s_waitcnt lgkmcnt(2)
    v_mfma_f32_16x16x32_bf16 v[24:27], v[20:23], v[40:43], v[24:27]
    v_lshlrev_b32 v120, 16, v40
    v_lshlrev_b32 v121, 16, v41
    v_mfma_f32_16x16x32_bf16 v[28:31], v[40:43], v[40:43], v[28:31]
    v_lshlrev_b32 v122, 16, v42
    v_lshlrev_b32 v123, 16, v43
    v_and_b32 v40, s58, v40
    v_and_b32 v41, s58, v41
    v_and_b32 v42, s58, v42
    v_and_b32 v43, s58, v43
    buffer_load_dwordx4 v235, s[8:11], s52 offen lds
    s_add_u32 m0, m0, 1024
    s_sub_u32 s52, s52, 512
    v_mfma_f32_16x16x32_bf16 v[24:27], v[20:23], v[44:47], v[24:27]
    v_lshlrev_b32 v124, 16, v44
    v_lshlrev_b32 v125, 16, v45
    v_mfma_f32_16x16x32_bf16 v[28:31], v[44:47], v[44:47], v[28:31]
    v_lshlrev_b32 v126, 16, v46
    v_lshlrev_b32 v127, 16, v47
    v_and_b32 v44, s58, v44
    v_and_b32 v45, s58, v45
    v_and_b32 v46, s58, v46
    v_and_b32 v47, s58, v47
    s_waitcnt vmcnt(6)
    ds_read_b128 v[48:51], v14 offset:8192
    ds_read_b128 v[52:55], v15 offset:8192
    buffer_load_dwordx4 v234, s[8:11], s52 offen lds
    s_add_u32 m0, m0, 1024
    s_nop 0
    s_waitcnt lgkmcnt(2)
    v_mfma_f32_16x16x32_bf16 v[24:27], v[20:23], v[80:83], v[24:27]
    v_lshlrev_b32 v160, 16, v80
    v_lshlrev_b32 v161, 16, v81
    v_mfma_f32_16x16x32_bf16 v[28:31], v[80:83], v[80:83], v[28:31]
    v_lshlrev_b32 v162, 16, v82
    v_lshlrev_b32 v163, 16, v83
    v_and_b32 v80, s58, v80
    v_and_b32 v81, s58, v81
    v_and_b32 v82, s58, v82
    v_and_b32 v83, s58, v83
    buffer_load_dwordx4 v235, s[8:11], s52 offen lds
    s_add_u32 m0, m0, 1024
    s_add_u32 s52, s52, 640
    v_mfma_f32_16x16x32_bf16 v[24:27], v[20:23], v[84:87], v[24:27]
    v_lshlrev_b32 v164, 16, v84
    v_lshlrev_b32 v165, 16, v85
    v_mfma_f32_16x16x32_bf16 v[28:31], v[84:87], v[84:87], v[28:31]
    v_lshlrev_b32 v166, 16, v86
    v_lshlrev_b32 v167, 16, v87
    v_and_b32 v84, s58, v84
    v_and_b32 v85, s58, v85
    v_and_b32 v86, s58, v86
    v_and_b32 v87, s58, v87
    s_waitcnt vmcnt(6)
    ds_read_b128 v[88:91], v14 offset:10240
    ds_read_b128 v[92:95], v15 offset:10240
    buffer_load_dwordx4 v234, s[8:11], s52 offen lds
    s_add_u32 m0, m0, 1024
    s_nop 0
    s_waitcnt lgkmcnt(2)
    v_mfma_f32_16x16x32_bf16 v[24:27], v[20:23], v[48:51], v[24:27]
    v_lshlrev_b32 v128, 16, v48
    v_lshlrev_b32 v129, 16, v49
    v_mfma_f32_16x16x32_bf16 v[28:31], v[48:51], v[48:51], v[28:31]
    v_lshlrev_b32 v130, 16, v50
    v_lshlrev_b32 v131, 16, v51
    v_and_b32 v48, s58, v48
    v_and_b32 v49, s58, v49
    v_and_b32 v50, s58, v50
    v_and_b32 v51, s58, v51
    buffer_load_dwordx4 v235, s[8:11], s52 offen lds
    s_mov_b32 m0, s55
    s_add_u32 s52, s52, 0
    v_mfma_f32_16x16x32_bf16 v[24:27], v[20:23], v[52:55], v[24:27]
    v_lshlrev_b32 v132, 16, v52
    v_lshlrev_b32 v133, 16, v53
    v_mfma_f32_16x16x32_bf16 v[28:31], v[52:55], v[52:55], v[28:31]
    v_lshlrev_b32 v134, 16, v54
    v_lshlrev_b32 v135, 16, v55
    v_and_b32 v52, s58, v52
    v_and_b32 v53, s58, v53
    v_and_b32 v54, s58, v54
    v_and_b32 v55, s58, v55
    s_waitcnt vmcnt(6)
    ds_read_b128 v[56:59], v14 offset:12288
    ds_read_b128 v[60:63], v15 offset:12288
    buffer_load_dwordx4 v237, s[12:15], s54 offen lds
    s_add_u32 m0, m0, 1024
    s_add_u32 s54, s54, 128
    s_waitcnt lgkmcnt(2)
    v_mfma_f32_16x16x32_bf16 v[24:27], v[20:23], v[88:91], v[24:27]
    v_lshlrev_b32 v168, 16, v88
    v_lshlrev_b32 v169, 16, v89
    v_mfma_f32_16x16x32_bf16 v[28:31], v[88:91], v[88:91], v[28:31]
    v_lshlrev_b32 v170, 16, v90
    v_lshlrev_b32 v171, 16, v91
    v_and_b32 v88, s58, v88
    v_and_b32 v89, s58, v89
    v_and_b32 v90, s58, v90
    v_and_b32 v91, s58, v91
    buffer_load_dwordx4 v237, s[12:15], s54 offen lds
    s_add_u32 m0, m0, 1024
    s_add_u32 s54, s54, 128
    v_mfma_f32_16x16x32_bf16 v[24:27], v[20:23], v[92:95], v[24:27]
    v_lshlrev_b32 v172, 16, v92
    v_lshlrev_b32 v173, 16, v93
    v_mfma_f32_16x16x32_bf16 v[28:31], v[92:95], v[92:95], v[28:31]
    v_lshlrev_b32 v174, 16, v94
    v_lshlrev_b32 v175, 16, v95
    v_and_b32 v92, s58, v92
    v_and_b32 v93, s58, v93
    v_and_b32 v94, s58, v94
    v_and_b32 v95, s58, v95
    s_waitcnt vmcnt(6)
    ds_read_b128 v[96:99], v14 offset:14336
    ds_read_b128 v[100:103], v15 offset:14336
    buffer_load_dwordx4 v237, s[12:15], s54 offen lds
    s_add_u32 m0, m0, 1024
    s_add_u32 s54, s54, 128
    s_waitcnt lgkmcnt(2)
    v_mfma_f32_16x16x32_bf16 v[24:27], v[20:23], v[56:59], v[24:27]
    v_lshlrev_b32 v136, 16, v56
    v_lshlrev_b32 v137, 16, v57
    v_mfma_f32_16x16x32_bf16 v[28:31], v[56:59], v[56:59], v[28:31]
    v_lshlrev_b32 v138, 16, v58
    v_lshlrev_b32 v139, 16, v59
    v_and_b32 v56, s58, v56
    v_and_b32 v57, s58, v57
    v_and_b32 v58, s58, v58
    v_and_b32 v59, s58, v59
    buffer_load_dwordx4 v237, s[12:15], s54 offen lds
    s_add_u32 m0, m0, 1024
    s_add_u32 s54, s54, 128
    v_mfma_f32_16x16x32_bf16 v[24:27], v[20:23], v[60:63], v[24:27]
    v_lshlrev_b32 v140, 16, v60
    v_lshlrev_b32 v141, 16, v61
    v_mfma_f32_16x16x32_bf16 v[28:31], v[60:63], v[60:63], v[28:31]
    v_lshlrev_b32 v142, 16, v62
    v_lshlrev_b32 v143, 16, v63
    v_and_b32 v60, s58, v60
    v_and_b32 v61, s58, v61
    v_and_b32 v62, s58, v62
    v_and_b32 v63, s58, v63
    s_waitcnt vmcnt(6)
    ds_read_b128 v[64:67], v14 offset:16384
    ds_read_b128 v[68:71], v15 offset:16384
    buffer_load_dwordx4 v237, s[12:15], s54 offen lds
    s_add_u32 m0, m0, 6144
    s_add_u32 s54, s54, 40448
    s_waitcnt lgkmcnt(2)
    v_mfma_f32_16x16x32_bf16 v[24:27], v[20:23], v[96:99], v[24:27]
    v_lshlrev_b32 v176, 16, v96
    v_lshlrev_b32 v177, 16, v97
    v_mfma_f32_16x16x32_bf16 v[28:31], v[96:99], v[96:99], v[28:31]
    v_lshlrev_b32 v178, 16, v98
    v_lshlrev_b32 v179, 16, v99
    v_and_b32 v96, s58, v96
    v_and_b32 v97, s58, v97
    v_and_b32 v98, s58, v98
    v_and_b32 v99, s58, v99
    buffer_load_dwordx4 v236, s[12:15], s54 offen lds
    s_add_u32 m0, m0, 1024
    s_add_u32 s54, s54, 128
    v_mfma_f32_16x16x32_bf16 v[24:27], v[20:23], v[100:103], v[24:27]
    v_lshlrev_b32 v180, 16, v100
    v_lshlrev_b32 v181, 16, v101
    v_mfma_f32_16x16x32_bf16 v[28:31], v[100:103], v[100:103], v[28:31]
    v_lshlrev_b32 v182, 16, v102
    v_lshlrev_b32 v183, 16, v103
    v_and_b32 v100, s58, v100
    v_and_b32 v101, s58, v101
    v_and_b32 v102, s58, v102
    v_and_b32 v103, s58, v103
    s_waitcnt vmcnt(6)
    ds_read_b128 v[104:107], v14 offset:18432
    ds_read_b128 v[108:111], v15 offset:18432
    buffer_load_dwordx4 v236, s[12:15], s54 offen lds
    s_add_u32 m0, m0, 1024
    s_add_u32 s54, s54, 128
    s_waitcnt lgkmcnt(2)
    v_mfma_f32_16x16x32_bf16 v[24:27], v[20:23], v[64:67], v[24:27]
    v_lshlrev_b32 v144, 16, v64
    v_lshlrev_b32 v145, 16, v65
    v_mfma_f32_16x16x32_bf16 v[28:31], v[64:67], v[64:67], v[28:31]
    v_lshlrev_b32 v146, 16, v66
    v_lshlrev_b32 v147, 16, v67
    v_and_b32 v64, s58, v64
    v_and_b32 v65, s58, v65
    v_and_b32 v66, s58, v66
    v_and_b32 v67, s58, v67
    buffer_load_dwordx4 v236, s[12:15], s54 offen lds
    s_add_u32 m0, m0, 1024
    s_add_u32 s54, s54, 128
    v_mfma_f32_16x16x32_bf16 v[24:27], v[20:23], v[68:71], v[24:27]
    v_lshlrev_b32 v148, 16, v68
    v_lshlrev_b32 v149, 16, v69
    v_mfma_f32_16x16x32_bf16 v[28:31], v[68:71], v[68:71], v[28:31]
    v_lshlrev_b32 v150, 16, v70
    v_lshlrev_b32 v151, 16, v71
    v_and_b32 v68, s58, v68
    v_and_b32 v69, s58, v69
    v_and_b32 v70, s58, v70
    v_and_b32 v71, s58, v71
    buffer_load_dwordx4 v236, s[12:15], s54 offen lds
    s_add_u32 m0, m0, 1024
    s_add_u32 s54, s54, 128
    s_waitcnt lgkmcnt(0)
    v_mfma_f32_16x16x32_bf16 v[24:27], v[20:23], v[104:107], v[24:27]
    v_lshlrev_b32 v184, 16, v104
    v_lshlrev_b32 v185, 16, v105
    v_mfma_f32_16x16x32_bf16 v[28:31], v[104:107], v[104:107], v[28:31]
    v_lshlrev_b32 v186, 16, v106
    v_lshlrev_b32 v187, 16, v107
    v_and_b32 v104, s58, v104
    v_and_b32 v105, s58, v105
    v_and_b32 v106, s58, v106
    v_and_b32 v107, s58, v107
    buffer_load_dwordx4 v236, s[12:15], s54 offen lds
    s_add_u32 m0, m0, 6144
    s_add_u32 s54, s54, 40448
    v_mfma_f32_16x16x32_bf16 v[24:27], v[20:23], v[108:111], v[24:27]
    v_lshlrev_b32 v188, 16, v108
    v_lshlrev_b32 v189, 16, v109
    v_mfma_f32_16x16x32_bf16 v[28:31], v[108:111], v[108:111], v[28:31]
    v_lshlrev_b32 v190, 16, v110
    v_lshlrev_b32 v191, 16, v111
    v_and_b32 v108, s58, v108
    v_and_b32 v109, s58, v109
    v_and_b32 v110, s58, v110
    v_and_b32 v111, s58, v111
    s_barrier
    s_bitcmp1_b32 s46, 1
    s_cbranch_scc0 L_wide
    s_mov_b32 exec_hi, 0xfffffff
    buffer_load_dword v247, v250, s[16:19], s69 offen
    s_mov_b32 exec_hi, -1
L_wide:
    buffer_load_dword v246, v252, s[36:39], 0 offen sc1
    s_movk_i32 s84, 1280
    s_mul_i32 s65, s50, 960
    v_add_u32 v6, 0, v1
    v_mul_i32_i24 v6, s89, v6
    v_add_u32 v6, s88, v6
    v_mul_u32_u24 v7, s84, v6
    v_sub_u32 v6, 2048, v6
    v_and_b32 v6, 2047, v6
    v_mul_u32_u24 v6, s84, v6
    s_mov_b64 exec, 0xffff
    buffer_load_ushort v242, v7, s[8:11], 0 offen offset:640
    buffer_load_ushort v244, v6, s[8:11], s65 offen
    s_mov_b64 exec, -1
    v_add_u32 v6, 16, v1
    v_mul_i32_i24 v6, s89, v6
    v_add_u32 v6, s88, v6
    v_mul_u32_u24 v7, s84, v6
    v_sub_u32 v6, 2048, v6
    v_and_b32 v6, 2047, v6
    v_mul_u32_u24 v6, s84, v6
    s_mov_b64 exec, 0xffff
    buffer_load_ushort v243, v7, s[8:11], 0 offen offset:640
    buffer_load_ushort v245, v6, s[8:11], s65 offen
    s_mov_b64 exec, -1
    s_bitcmp1_b32 s46, 1
    s_cbranch_scc1 L_wr0
    buffer_load_dwordx4 v236, s[12:15], s54 offen lds
    s_add_u32 m0, m0, 1024
    s_add_u32 s54, s54, 128
L_wr0:
    v_pk_fma_f32 v[32:33], v[72:73], s[96:97], v[32:33]
    v_pk_fma_f32 v[34:35], v[74:75], s[96:97], v[34:35]
    v_pk_fma_f32 v[36:37], v[76:77], s[96:97], v[36:37]
    v_pk_fma_f32 v[38:39], v[78:79], s[96:97], v[38:39]
    v_pk_fma_f32 v[40:41], v[80:81], s[96:97], v[40:41]
    v_pk_fma_f32 v[42:43], v[82:83], s[96:97], v[42:43]
    v_pk_fma_f32 v[44:45], v[84:85], s[96:97], v[44:45]
    v_pk_fma_f32 v[46:47], v[86:87], s[96:97], v[46:47]
    v_pk_fma_f32 v[48:49], v[88:89], s[96:97], v[48:49]
    s_bitcmp1_b32 s46, 1
    s_cbranch_scc1 L_wr1
    buffer_load_dwordx4 v236, s[12:15], s54 offen lds
    s_add_u32 m0, m0, 1024
    s_add_u32 s54, s54, 128
L_wr1:
    v_pk_fma_f32 v[50:51], v[90:91], s[96:97], v[50:51]
    v_pk_fma_f32 v[52:53], v[92:93], s[96:97], v[52:53]
    v_pk_fma_f32 v[54:55], v[94:95], s[96:97], v[54:55]
    v_pk_fma_f32 v[56:57], v[96:97], s[96:97], v[56:57]
    v_pk_fma_f32 v[58:59], v[98:99], s[96:97], v[58:59]
    v_pk_fma_f32 v[60:61], v[100:101], s[96:97], v[60:61]
    v_pk_fma_f32 v[62:63], v[102:103], s[96:97], v[62:63]
    v_pk_fma_f32 v[64:65], v[104:105], s[96:97], v[64:65]
    v_pk_fma_f32 v[66:67], v[106:107], s[96:97], v[66:67]
    s_bitcmp1_b32 s46, 1
    s_cbranch_scc1 L_wr2
    buffer_load_dwordx4 v236, s[12:15], s54 offen lds
    s_add_u32 m0, m0, 1024
    s_add_u32 s54, s54, 128
L_wr2:
    v_pk_fma_f32 v[68:69], v[108:109], s[96:97], v[68:69]
    v_pk_fma_f32 v[70:71], v[110:111], s[96:97], v[70:71]
    v_pk_fma_f32 v[112:113], v[152:153], s[96:97], v[112:113]
    v_pk_fma_f32 v[114:115], v[154:155], s[96:97], v[114:115]
    v_pk_fma_f32 v[116:117], v[156:157], s[96:97], v[116:117]
    v_pk_fma_f32 v[118:119], v[158:159], s[96:97], v[118:119]
    v_pk_fma_f32 v[120:121], v[160:161], s[96:97], v[120:121]
    v_pk_fma_f32 v[122:123], v[162:163], s[96:97], v[122:123]
    v_pk_fma_f32 v[124:125], v[164:165], s[96:97], v[124:125]
    s_bitcmp1_b32 s46, 1
    s_cbranch_scc1 L_wr3
    buffer_load_dwordx4 v236, s[12:15], s54 offen lds
    s_add_u32 m0, m0, 1024
    s_add_u32 s54, s54, 128
L_wr3:
    v_pk_fma_f32 v[126:127], v[166:167], s[96:97], v[126:127]
    v_pk_fma_f32 v[128:129], v[168:169], s[96:97], v[128:129]
    v_pk_fma_f32 v[130:131], v[170:171], s[96:97], v[130:131]
    v_pk_fma_f32 v[132:133], v[172:173], s[96:97], v[132:133]
    v_pk_fma_f32 v[134:135], v[174:175], s[96:97], v[134:135]
    v_pk_fma_f32 v[136:137], v[176:177], s[96:97], v[136:137]
    v_pk_fma_f32 v[138:139], v[178:179], s[96:97], v[138:139]
    v_pk_fma_f32 v[140:141], v[180:181], s[96:97], v[140:141]
    v_pk_fma_f32 v[142:143], v[182:183], s[96:97], v[142:143]
    s_bitcmp1_b32 s46, 1
    s_cbranch_scc1 L_wr4
    buffer_load_dwordx4 v236, s[12:15], s54 offen lds
    s_add_u32 m0, m0, 6144
    s_add_u32 s54, s54, 40448
L_wr4:
    v_pk_fma_f32 v[144:145], v[184:185], s[96:97], v[144:145]
    s_add_u32 m0, s73, 0
    s_mov_b32 s72, s60
    v_pk_fma_f32 v[146:147], v[186:187], s[96:97], v[146:147]
    v_pk_fma_f32 v[148:149], v[188:189], s[96:97], v[148:149]
    v_pk_fma_f32 v[150:151], v[190:191], s[96:97], v[150:151]
    v_and_b32 v4, 3, v1
    v_cmp_eq_u32 vcc, 1, v4
    v_lshrrev_b32 v5, 2, v1
    v_lshl_add_u32 v5, v5, 4, v1
    v_cndmask_b32 v28, v28, v29, vcc
    buffer_load_dwordx4 v9, s[8:11], s72 offen lds
    v_cmp_eq_u32 vcc, 2, v4
    s_add_u32 m0, m0, s74
    s_add_u32 s72, s72, s75
    v_lshlrev_b32 v5, 2, v5
    v_mul_f32 v6, 0x3acccccd, v24
    v_cndmask_b32 v28, v28, v30, vcc
    v_cmp_eq_u32 vcc, 3, v4
    v_mov_b32 v7, 0x3727c5ac
    v_fma_f32 v7, -v6, v6, v7
    v_cndmask_b32 v28, v28, v31, vcc
    ds_bpermute_b32 v4, v5, v28
    buffer_load_dwordx4 v9, s[8:11], s72 offen lds
    s_waitcnt lgkmcnt(0)
    s_add_u32 m0, m0, s74
    s_add_u32 s72, s72, s75
    v_fmac_f32 v7, 0x3acccccd, v4
    v_rsq_f32 v6, v7
    v_mul_f32 v7, s59, v24
    v_mul_f32 v7, v6, v7
    v_pk_fma_f32 v[32:33], v[32:33], v[6:7], v[6:7] op_sel:[0,0,1] op_sel_hi:[1,0,1]
    v_pk_fma_f32 v[34:35], v[34:35], v[6:7], v[6:7] op_sel:[0,0,1] op_sel_hi:[1,0,1]
    v_pk_fma_f32 v[112:113], v[112:113], v[6:7], v[6:7] op_sel:[0,0,1] op_sel_hi:[1,0,1]
    v_pk_fma_f32 v[114:115], v[114:115], v[6:7], v[6:7] op_sel:[0,0,1] op_sel_hi:[1,0,1]
    buffer_load_dwordx4 v9, s[8:11], s72 offen lds
    v_pk_fma_f32 v[36:37], v[36:37], v[6:7], v[6:7] op_sel:[0,0,1] op_sel_hi:[1,0,1]
    s_add_u32 m0, m0, s74
    s_add_u32 s72, s72, s75
    v_pk_fma_f32 v[38:39], v[38:39], v[6:7], v[6:7] op_sel:[0,0,1] op_sel_hi:[1,0,1]
    v_pk_fma_f32 v[116:117], v[116:117], v[6:7], v[6:7] op_sel:[0,0,1] op_sel_hi:[1,0,1]
    v_pk_fma_f32 v[118:119], v[118:119], v[6:7], v[6:7] op_sel:[0,0,1] op_sel_hi:[1,0,1]
    v_pk_fma_f32 v[40:41], v[40:41], v[6:7], v[6:7] op_sel:[0,0,1] op_sel_hi:[1,0,1]
    v_pk_fma_f32 v[42:43], v[42:43], v[6:7], v[6:7] op_sel:[0,0,1] op_sel_hi:[1,0,1]
    v_pk_fma_f32 v[120:121], v[120:121], v[6:7], v[6:7] op_sel:[0,0,1] op_sel_hi:[1,0,1]
    v_pk_fma_f32 v[122:123], v[122:123], v[6:7], v[6:7] op_sel:[0,0,1] op_sel_hi:[1,0,1]
    v_pk_fma_f32 v[44:45], v[44:45], v[6:7], v[6:7] op_sel:[0,0,1] op_sel_hi:[1,0,1]
    buffer_load_dwordx4 v9, s[8:11], s72 offen lds
    v_pk_fma_f32 v[46:47], v[46:47], v[6:7], v[6:7] op_sel:[0,0,1] op_sel_hi:[1,0,1]
    s_add_u32 m0, m0, s74
    s_add_u32 s72, s72, s75
    v_pk_fma_f32 v[124:125], v[124:125], v[6:7], v[6:7] op_sel:[0,0,1] op_sel_hi:[1,0,1]
    v_pk_fma_f32 v[126:127], v[126:127], v[6:7], v[6:7] op_sel:[0,0,1] op_sel_hi:[1,0,1]
    v_pk_fma_f32 v[48:49], v[48:49], v[6:7], v[6:7] op_sel:[0,0,1] op_sel_hi:[1,0,1]
    v_pk_fma_f32 v[50:51], v[50:51], v[6:7], v[6:7] op_sel:[0,0,1] op_sel_hi:[1,0,1]
    v_pk_fma_f32 v[128:129], v[128:129], v[6:7], v[6:7] op_sel:[0,0,1] op_sel_hi:[1,0,1]
    v_pk_fma_f32 v[130:131], v[130:131], v[6:7], v[6:7] op_sel:[0,0,1] op_sel_hi:[1,0,1]
    v_pk_fma_f32 v[52:53], v[52:53], v[6:7], v[6:7] op_sel:[0,0,1] op_sel_hi:[1,0,1]
    v_pk_fma_f32 v[54:55], v[54:55], v[6:7], v[6:7] op_sel:[0,0,1] op_sel_hi:[1,0,1]
    buffer_load_dwordx4 v9, s[8:11], s72 offen lds
    v_pk_fma_f32 v[132:133], v[132:133], v[6:7], v[6:7] op_sel:[0,0,1] op_sel_hi:[1,0,1]
    s_add_u32 m0, s73, 10240
    s_mov_b32 s72, s61
    v_pk_fma_f32 v[134:135], v[134:135], v[6:7], v[6:7] op_sel:[0,0,1] op_sel_hi:[1,0,1]
    v_pk_fma_f32 v[56:57], v[56:57], v[6:7], v[6:7] op_sel:[0,0,1] op_sel_hi:[1,0,1]
    v_pk_fma_f32 v[58:59], v[58:59], v[6:7], v[6:7] op_sel:[0,0,1] op_sel_hi:[1,0,1]
    v_pk_fma_f32 v[136:137], v[136:137], v[6:7], v[6:7] op_sel:[0,0,1] op_sel_hi:[1,0,1]
    v_pk_fma_f32 v[138:139], v[138:139], v[6:7], v[6:7] op_sel:[0,0,1] op_sel_hi:[1,0,1]
    v_pk_fma_f32 v[60:61], v[60:61], v[6:7], v[6:7] op_sel:[0,0,1] op_sel_hi:[1,0,1]
    v_pk_fma_f32 v[62:63], v[62:63], v[6:7], v[6:7] op_sel:[0,0,1] op_sel_hi:[1,0,1]
    v_pk_fma_f32 v[140:141], v[140:141], v[6:7], v[6:7] op_sel:[0,0,1] op_sel_hi:[1,0,1]
    buffer_load_dwordx4 v11, s[8:11], s72 offen lds
    v_pk_fma_f32 v[142:143], v[142:143], v[6:7], v[6:7] op_sel:[0,0,1] op_sel_hi:[1,0,1]
    s_add_u32 m0, m0, s74
    s_sub_u32 s72, s72, s75
    v_pk_fma_f32 v[64:65], v[64:65], v[6:7], v[6:7] op_sel:[0,0,1] op_sel_hi:[1,0,1]
    v_pk_fma_f32 v[66:67], v[66:67], v[6:7], v[6:7] op_sel:[0,0,1] op_sel_hi:[1,0,1]
    v_pk_fma_f32 v[144:145], v[144:145], v[6:7], v[6:7] op_sel:[0,0,1] op_sel_hi:[1,0,1]
    v_pk_fma_f32 v[146:147], v[146:147], v[6:7], v[6:7] op_sel:[0,0,1] op_sel_hi:[1,0,1]
    v_pk_fma_f32 v[68:69], v[68:69], v[6:7], v[6:7] op_sel:[0,0,1] op_sel_hi:[1,0,1]
    v_pk_fma_f32 v[70:71], v[70:71], v[6:7], v[6:7] op_sel:[0,0,1] op_sel_hi:[1,0,1]
    v_pk_fma_f32 v[148:149], v[148:149], v[6:7], v[6:7] op_sel:[0,0,1] op_sel_hi:[1,0,1]
    v_pk_fma_f32 v[150:151], v[150:151], v[6:7], v[6:7] op_sel:[0,0,1] op_sel_hi:[1,0,1]
    buffer_load_dwordx4 v11, s[8:11], s72 offen lds
    v_cvt_pk_bf16_f32 v72, v112, v32
    s_add_u32 m0, m0, s74
    s_sub_u32 s72, s72, s75
    v_cvt_pk_bf16_f32 v73, v113, v33
    v_cvt_pk_bf16_f32 v74, v114, v34
    v_cvt_pk_bf16_f32 v75, v115, v35
    v_cvt_pk_bf16_f32 v76, v116, v36
    v_cvt_pk_bf16_f32 v77, v117, v37
    v_cvt_pk_bf16_f32 v78, v118, v38
    v_cvt_pk_bf16_f32 v79, v119, v39
    v_cvt_pk_bf16_f32 v80, v120, v40
    buffer_load_dwordx4 v11, s[8:11], s72 offen lds
    v_cvt_pk_bf16_f32 v81, v121, v41
    s_add_u32 m0, m0, s74
    s_sub_u32 s72, s72, s75
    v_cvt_pk_bf16_f32 v82, v122, v42
    v_cvt_pk_bf16_f32 v83, v123, v43
    v_cvt_pk_bf16_f32 v84, v124, v44
    v_cvt_pk_bf16_f32 v85, v125, v45
    v_cvt_pk_bf16_f32 v86, v126, v46
    v_cvt_pk_bf16_f32 v87, v127, v47
    v_cvt_pk_bf16_f32 v88, v128, v48
    v_cvt_pk_bf16_f32 v89, v129, v49
    buffer_load_dwordx4 v11, s[8:11], s72 offen lds
    v_cvt_pk_bf16_f32 v90, v130, v50
    s_add_u32 m0, m0, s74
    s_sub_u32 s72, s72, s75
    v_cvt_pk_bf16_f32 v91, v131, v51
    v_cvt_pk_bf16_f32 v92, v132, v52
    v_cvt_pk_bf16_f32 v93, v133, v53
    v_cvt_pk_bf16_f32 v94, v134, v54
    v_cvt_pk_bf16_f32 v95, v135, v55
    v_cvt_pk_bf16_f32 v96, v136, v56
    v_cvt_pk_bf16_f32 v97, v137, v57
    v_cvt_pk_bf16_f32 v98, v138, v58
    buffer_load_dwordx4 v11, s[8:11], s72 offen lds
    v_cvt_pk_bf16_f32 v99, v139, v59
    v_cvt_pk_bf16_f32 v100, v140, v60
    v_cvt_pk_bf16_f32 v101, v141, v61
    v_cvt_pk_bf16_f32 v102, v142, v62
    v_cvt_pk_bf16_f32 v103, v143, v63
    v_cvt_pk_bf16_f32 v104, v144, v64
    v_cvt_pk_bf16_f32 v105, v145, v65
    v_cvt_pk_bf16_f32 v106, v146, v66
    v_cvt_pk_bf16_f32 v107, v147, v67
    v_cvt_pk_bf16_f32 v108, v148, v68
    v_cvt_pk_bf16_f32 v109, v149, v69
    v_cvt_pk_bf16_f32 v110, v150, v70
    v_cvt_pk_bf16_f32 v111, v151, v71
    s_bitcmp1_b32 s46, 1
    s_cbranch_scc0 L_wide2
    s_waitcnt vmcnt(16)
    s_branch L_wd3
L_wide2:
    s_waitcnt vmcnt(10)
L_wd3:
    s_barrier
    ds_read_b128 v[112:115], v16 offset:0
    ds_read_b128 v[116:119], v16 offset:10240
    ds_read_b128 v[120:123], v16 offset:20480
    ds_read_b128 v[124:127], v16 offset:30720
    ds_read_b128 v[128:131], v16 offset:40960
    ds_read_b128 v[132:135], v16 offset:51200
    ds_read_b128 v[136:139], v17 offset:0
    ds_read_b128 v[140:143], v17 offset:10240
    ds_read_b128 v[144:147], v17 offset:20480
    ds_read_b128 v[148:151], v17 offset:30720
    ds_read_b128 v[152:155], v17 offset:40960
    ds_read_b128 v[156:159], v17 offset:51200
    s_and_b32 s84, s48, 3
    s_lshl_b32 s84, s84, 2
    s_lshl_b32 s85, s50, 4
    s_add_u32 s84, s84, s85
    v_add_u32 v6, s84, v2
    v_mul_i32_i24 v6, s89, v6
    v_add_u32 v6, s88, v6
    v_lshlrev_b32 v6, 12, v6
    v_and_b32 v7, 12, v0
    v_lshl_add_u32 v6, v7, 8, v6
    v_and_b32 v7, 3, v0
    v_lshl_add_u32 v6, v7, 7, v6
    s_mov_b32 exec_lo, 0x33333333
    s_mov_b32 exec_hi, 0x33333333
    buffer_load_dword v247, v6, s[20:23], 0 offen offset:0
    s_mov_b64 exec, -1
    s_waitcnt lgkmcnt(6)
    v_mfma_f32_16x16x32_bf16 v[32:35], v[72:75], v[112:115], 0
    ds_read_b128 v[160:163], v16 offset:1024
    v_mfma_f32_16x16x32_bf16 v[36:39], v[72:75], v[116:119], 0
    ds_read_b128 v[164:167], v16 offset:11264
    v_mfma_f32_16x16x32_bf16 v[40:43], v[72:75], v[120:123], 0
    ds_read_b128 v[168:171], v16 offset:21504
    v_mfma_f32_16x16x32_bf16 v[44:47], v[72:75], v[124:127], 0
    ds_read_b128 v[172:175], v16 offset:31744
    v_mfma_f32_16x16x32_bf16 v[48:51], v[72:75], v[128:131], 0
    ds_read_b128 v[176:179], v16 offset:41984
    v_mfma_f32_16x16x32_bf16 v[52:55], v[72:75], v[132:135], 0
    ds_read_b128 v[180:183], v16 offset:52224
    s_waitcnt lgkmcnt(6)
    v_mfma_f32_16x16x32_bf16 v[32:35], v[76:79], v[136:139], v[32:35]
    ds_read_b128 v[112:115], v17 offset:1024
    v_mfma_f32_16x16x32_bf16 v[36:39], v[76:79], v[140:143], v[36:39]
    ds_read_b128 v[116:119], v17 offset:11264
    v_mfma_f32_16x16x32_bf16 v[40:43], v[76:79], v[144:147], v[40:43]
    ds_read_b128 v[120:123], v17 offset:21504
    v_mfma_f32_16x16x32_bf16 v[44:47], v[76:79], v[148:151], v[44:47]
    ds_read_b128 v[124:127], v17 offset:31744
    v_mfma_f32_16x16x32_bf16 v[48:51], v[76:79], v[152:155], v[48:51]
    ds_read_b128 v[128:131], v17 offset:41984
    v_mfma_f32_16x16x32_bf16 v[52:55], v[76:79], v[156:159], v[52:55]
    ds_read_b128 v[132:135], v17 offset:52224
    s_waitcnt lgkmcnt(6)
    v_mfma_f32_16x16x32_bf16 v[32:35], v[80:83], v[160:163], v[32:35]
    ds_read_b128 v[136:139], v16 offset:2048
    v_mfma_f32_16x16x32_bf16 v[36:39], v[80:83], v[164:167], v[36:39]
    ds_read_b128 v[140:143], v16 offset:12288
    s_add_u32 m0, s73, 5120
    s_mov_b32 s72, s60
    v_mfma_f32_16x16x32_bf16 v[40:43], v[80:83], v[168:171], v[40:43]
    ds_read_b128 v[144:147], v16 offset:22528
    v_mfma_f32_16x16x32_bf16 v[44:47], v[80:83], v[172:175], v[44:47]
    ds_read_b128 v[148:151], v16 offset:32768
    v_mfma_f32_16x16x32_bf16 v[48:51], v[80:83], v[176:179], v[48:51]
    ds_read_b128 v[152:155], v16 offset:43008
    v_mfma_f32_16x16x32_bf16 v[52:55], v[80:83], v[180:183], v[52:55]
    ds_read_b128 v[156:159], v16 offset:53248
    buffer_load_dwordx4 v10, s[8:11], s72 offen lds
    s_waitcnt lgkmcnt(6)
    v_mfma_f32_16x16x32_bf16 v[32:35], v[84:87], v[112:115], v[32:35]
    ds_read_b128 v[160:163], v17 offset:2048
    v_mfma_f32_16x16x32_bf16 v[36:39], v[84:87], v[116:119], v[36:39]
    ds_read_b128 v[164:167], v17 offset:12288
    v_mfma_f32_16x16x32_bf16 v[40:43], v[84:87], v[120:123], v[40:43]
    ds_read_b128 v[168:171], v17 offset:22528
    v_mfma_f32_16x16x32_bf16 v[44:47], v[84:87], v[124:127], v[44:47]
    ds_read_b128 v[172:175], v17 offset:32768
    v_mfma_f32_16x16x32_bf16 v[48:51], v[84:87], v[128:131], v[48:51]
    ds_read_b128 v[176:179], v17 offset:43008
    v_mfma_f32_16x16x32_bf16 v[52:55], v[84:87], v[132:135], v[52:55]
    ds_read_b128 v[180:183], v17 offset:53248
    s_waitcnt lgkmcnt(6)
    v_mfma_f32_16x16x32_bf16 v[32:35], v[88:91], v[136:139], v[32:35]
    ds_read_b128 v[112:115], v16 offset:3072
    v_mfma_f32_16x16x32_bf16 v[36:39], v[88:91], v[140:143], v[36:39]
    ds_read_b128 v[116:119], v16 offset:13312
    s_add_u32 m0, m0, s74
    s_add_u32 s72, s72, s75
    v_mfma_f32_16x16x32_bf16 v[40:43], v[88:91], v[144:147], v[40:43]
    ds_read_b128 v[120:123], v16 offset:23552
    v_mfma_f32_16x16x32_bf16 v[44:47], v[88:91], v[148:151], v[44:47]
    ds_read_b128 v[124:127], v16 offset:33792
    v_mfma_f32_16x16x32_bf16 v[48:51], v[88:91], v[152:155], v[48:51]
    ds_read_b128 v[128:131], v16 offset:44032
    v_mfma_f32_16x16x32_bf16 v[52:55], v[88:91], v[156:159], v[52:55]
    ds_read_b128 v[132:135], v16 offset:54272
    buffer_load_dwordx4 v10, s[8:11], s72 offen lds
    s_waitcnt lgkmcnt(6)
    v_mfma_f32_16x16x32_bf16 v[32:35], v[92:95], v[160:163], v[32:35]
    ds_read_b128 v[136:139], v17 offset:3072
    v_mfma_f32_16x16x32_bf16 v[36:39], v[92:95], v[164:167], v[36:39]
    ds_read_b128 v[140:143], v17 offset:13312
    v_mfma_f32_16x16x32_bf16 v[40:43], v[92:95], v[168:171], v[40:43]
    ds_read_b128 v[144:147], v17 offset:23552
    v_mfma_f32_16x16x32_bf16 v[44:47], v[92:95], v[172:175], v[44:47]
    ds_read_b128 v[148:151], v17 offset:33792
    v_mfma_f32_16x16x32_bf16 v[48:51], v[92:95], v[176:179], v[48:51]
    ds_read_b128 v[152:155], v17 offset:44032
    v_mfma_f32_16x16x32_bf16 v[52:55], v[92:95], v[180:183], v[52:55]
    ds_read_b128 v[156:159], v17 offset:54272
    s_waitcnt lgkmcnt(6)
    v_mfma_f32_16x16x32_bf16 v[32:35], v[96:99], v[112:115], v[32:35]
    ds_read_b128 v[160:163], v16 offset:4096
    v_mfma_f32_16x16x32_bf16 v[36:39], v[96:99], v[116:119], v[36:39]
    ds_read_b128 v[164:167], v16 offset:14336
    v_mfma_f32_16x16x32_bf16 v[40:43], v[96:99], v[120:123], v[40:43]
    ds_read_b128 v[168:171], v16 offset:24576
    v_mfma_f32_16x16x32_bf16 v[44:47], v[96:99], v[124:127], v[44:47]
    ds_read_b128 v[172:175], v16 offset:34816
    v_mfma_f32_16x16x32_bf16 v[48:51], v[96:99], v[128:131], v[48:51]
    ds_read_b128 v[176:179], v16 offset:45056
    v_mfma_f32_16x16x32_bf16 v[52:55], v[96:99], v[132:135], v[52:55]
    ds_read_b128 v[180:183], v16 offset:55296
    s_waitcnt lgkmcnt(6)
    v_mfma_f32_16x16x32_bf16 v[32:35], v[100:103], v[136:139], v[32:35]
    ds_read_b128 v[112:115], v17 offset:4096
    v_mfma_f32_16x16x32_bf16 v[36:39], v[100:103], v[140:143], v[36:39]
    ds_read_b128 v[116:119], v17 offset:14336
    s_add_u32 m0, m0, s74
    s_add_u32 s72, s72, s75
    v_mfma_f32_16x16x32_bf16 v[40:43], v[100:103], v[144:147], v[40:43]
    ds_read_b128 v[120:123], v17 offset:24576
    v_mfma_f32_16x16x32_bf16 v[44:47], v[100:103], v[148:151], v[44:47]
    ds_read_b128 v[124:127], v17 offset:34816
    v_mfma_f32_16x16x32_bf16 v[48:51], v[100:103], v[152:155], v[48:51]
    ds_read_b128 v[128:131], v17 offset:45056
    v_mfma_f32_16x16x32_bf16 v[52:55], v[100:103], v[156:159], v[52:55]
    ds_read_b128 v[132:135], v17 offset:55296
    buffer_load_dwordx4 v10, s[8:11], s72 offen lds
    s_waitcnt lgkmcnt(6)
    v_mfma_f32_16x16x32_bf16 v[32:35], v[104:107], v[160:163], v[32:35]
    v_mfma_f32_16x16x32_bf16 v[36:39], v[104:107], v[164:167], v[36:39]
    v_mfma_f32_16x16x32_bf16 v[40:43], v[104:107], v[168:171], v[40:43]
    v_mfma_f32_16x16x32_bf16 v[44:47], v[104:107], v[172:175], v[44:47]
    v_mfma_f32_16x16x32_bf16 v[48:51], v[104:107], v[176:179], v[48:51]
    s_add_u32 m0, m0, s74
    s_add_u32 s72, s72, s75
    v_mfma_f32_16x16x32_bf16 v[52:55], v[104:107], v[180:183], v[52:55]
    s_waitcnt lgkmcnt(0)
    v_mfma_f32_16x16x32_bf16 v[32:35], v[108:111], v[112:115], v[32:35]
    v_mfma_f32_16x16x32_bf16 v[36:39], v[108:111], v[116:119], v[36:39]
    v_mfma_f32_16x16x32_bf16 v[40:43], v[108:111], v[120:123], v[40:43]
    v_mfma_f32_16x16x32_bf16 v[44:47], v[108:111], v[124:127], v[44:47]
    v_mfma_f32_16x16x32_bf16 v[48:51], v[108:111], v[128:131], v[48:51]
    v_mfma_f32_16x16x32_bf16 v[52:55], v[108:111], v[132:135], v[52:55]
    buffer_load_dwordx4 v10, s[8:11], s72 offen lds
    s_nop 3
    v_cvt_pk_bf16_f32 v56, v32, v33
    v_cvt_pk_bf16_f32 v57, v34, v35
    ds_write_b64 v18, v[56:57] offset:0
    v_cvt_pk_bf16_f32 v58, v36, v37
    v_cvt_pk_bf16_f32 v59, v38, v39
    ds_write_b64 v18, v[58:59] offset:2048
    v_cvt_pk_bf16_f32 v60, v40, v41
    v_cvt_pk_bf16_f32 v61, v42, v43
    ds_write_b64 v18, v[60:61] offset:4096
    v_cvt_pk_bf16_f32 v62, v44, v45
    v_cvt_pk_bf16_f32 v63, v46, v47
    ds_write_b64 v18, v[62:63] offset:6144
    v_cvt_pk_bf16_f32 v64, v48, v49
    v_cvt_pk_bf16_f32 v65, v50, v51
    ds_write_b64 v18, v[64:65] offset:8192
    v_cvt_pk_bf16_f32 v66, v52, v53
    v_cvt_pk_bf16_f32 v67, v54, v55
    ds_write_b64 v18, v[66:67] offset:10240
    s_waitcnt lgkmcnt(0)
    s_barrier
    ds_read_b128 v[32:35], v232 offset:0
    ds_read_b128 v[36:39], v233 offset:0
    ds_read_b128 v[40:43], v232 offset:6144
    ds_read_b128 v[44:47], v233 offset:6144
    ds_read_b128 v[48:51], v232 offset:2048
    ds_read_b128 v[52:55], v233 offset:2048
    ds_read_b128 v[56:59], v232 offset:8192
    ds_read_b128 v[60:63], v233 offset:8192
    ds_read_b128 v[64:67], v232 offset:4096
    ds_read_b128 v[68:71], v233 offset:4096
    ds_read_b128 v[72:75], v232 offset:10240
    ds_read_b128 v[76:79], v233 offset:10240
    s_lshl_b32 s54, s44, 4
    v_add_u32 v4, s54, v1
    v_mul_u32_u24 v4, 40960, v4
    v_lshl_add_u32 v4, v2, 4, v4
    s_mul_i32 s54, s45, 1280
    s_lshr_b32 s55, s46, 2
    s_lshl_b32 s55, s55, 6
    s_add_u32 s54, s54, s55
    s_lshl_b32 s55, s82, 3
    s_add_u32 s54, s54, s55
    s_bitcmp1_b32 s45, 2
    s_cbranch_scc1 L_s1_sw
    s_add_u32 m0, m0, s74
    s_add_u32 s72, s72, s75
    s_waitcnt lgkmcnt(8)
    v_mfma_f32_16x16x32_bf16 v[80:83], v[32:35], v[192:195], 0
    v_mfma_f32_16x16x32_bf16 v[84:87], v[32:35], v[200:203], 0
    buffer_load_dwordx4 v10, s[8:11], s72 offen lds
    s_add_u32 m0, s73, 15360
    s_mov_b32 s72, s61
    v_mfma_f32_16x16x32_bf16 v[80:83], v[36:39], v[196:199], v[80:83]
    v_mfma_f32_16x16x32_bf16 v[84:87], v[36:39], v[204:207], v[84:87]
    v_mfma_f32_16x16x32_bf16 v[80:83], v[40:43], v[208:211], v[80:83]
    v_mfma_f32_16x16x32_bf16 v[84:87], v[40:43], v[192:195], v[84:87]
    buffer_load_dwordx4 v12, s[8:11], s72 offen lds
    s_add_u32 m0, m0, s74
    s_sub_u32 s72, s72, s75
    v_mfma_f32_16x16x32_bf16 v[80:83], v[44:47], v[212:215], v[80:83]
    v_mfma_f32_16x16x32_bf16 v[84:87], v[44:47], v[196:199], v[84:87]
    s_waitcnt lgkmcnt(4)
    v_mfma_f32_16x16x32_bf16 v[88:91], v[48:51], v[192:195], 0
    v_mfma_f32_16x16x32_bf16 v[92:95], v[48:51], v[200:203], 0
    buffer_load_dwordx4 v12, s[8:11], s72 offen lds
    s_add_u32 m0, m0, s74
    s_sub_u32 s72, s72, s75
    v_mfma_f32_16x16x32_bf16 v[88:91], v[52:55], v[196:199], v[88:91]
    v_mfma_f32_16x16x32_bf16 v[92:95], v[52:55], v[204:207], v[92:95]
    v_mfma_f32_16x16x32_bf16 v[88:91], v[56:59], v[208:211], v[88:91]
    v_mfma_f32_16x16x32_bf16 v[92:95], v[56:59], v[192:195], v[92:95]
    buffer_load_dwordx4 v12, s[8:11], s72 offen lds
    s_add_u32 m0, m0, s74
    s_sub_u32 s72, s72, s75
    v_mfma_f32_16x16x32_bf16 v[88:91], v[60:63], v[212:215], v[88:91]
    v_mfma_f32_16x16x32_bf16 v[92:95], v[60:63], v[196:199], v[92:95]
    s_waitcnt lgkmcnt(0)
    v_mfma_f32_16x16x32_bf16 v[96:99], v[64:67], v[192:195], 0
    v_mfma_f32_16x16x32_bf16 v[100:103], v[64:67], v[200:203], 0
    buffer_load_dwordx4 v12, s[8:11], s72 offen lds
    s_add_u32 m0, m0, s74
    s_sub_u32 s72, s72, s75
    v_mfma_f32_16x16x32_bf16 v[96:99], v[68:71], v[196:199], v[96:99]
    v_mfma_f32_16x16x32_bf16 v[100:103], v[68:71], v[204:207], v[100:103]
    v_mfma_f32_16x16x32_bf16 v[96:99], v[72:75], v[208:211], v[96:99]
    v_mfma_f32_16x16x32_bf16 v[100:103], v[72:75], v[192:195], v[100:103]
    buffer_load_dwordx4 v12, s[8:11], s72 offen lds
    v_mfma_f32_16x16x32_bf16 v[96:99], v[76:79], v[212:215], v[96:99]
    v_mfma_f32_16x16x32_bf16 v[100:103], v[76:79], v[196:199], v[100:103]
    s_branch L_s1_done
L_s1_sw:
    s_add_u32 m0, m0, s74
    s_add_u32 s72, s72, s75
    s_waitcnt lgkmcnt(8)
    v_mfma_f32_16x16x32_bf16 v[80:83], v[32:35], v[200:203], 0
    v_mfma_f32_16x16x32_bf16 v[84:87], v[32:35], v[192:195], 0
    buffer_load_dwordx4 v10, s[8:11], s72 offen lds
    s_add_u32 m0, s73, 15360
    s_mov_b32 s72, s61
    v_mfma_f32_16x16x32_bf16 v[80:83], v[36:39], v[204:207], v[80:83]
    v_mfma_f32_16x16x32_bf16 v[84:87], v[36:39], v[196:199], v[84:87]
    v_mfma_f32_16x16x32_bf16 v[80:83], v[40:43], v[192:195], v[80:83]
    v_mfma_f32_16x16x32_bf16 v[84:87], v[40:43], v[208:211], v[84:87]
    buffer_load_dwordx4 v12, s[8:11], s72 offen lds
    s_add_u32 m0, m0, s74
    s_sub_u32 s72, s72, s75
    v_mfma_f32_16x16x32_bf16 v[80:83], v[44:47], v[196:199], v[80:83]
    v_mfma_f32_16x16x32_bf16 v[84:87], v[44:47], v[212:215], v[84:87]
    s_waitcnt lgkmcnt(4)
    v_mfma_f32_16x16x32_bf16 v[88:91], v[48:51], v[200:203], 0
    v_mfma_f32_16x16x32_bf16 v[92:95], v[48:51], v[192:195], 0
    buffer_load_dwordx4 v12, s[8:11], s72 offen lds
    s_add_u32 m0, m0, s74
    s_sub_u32 s72, s72, s75
    v_mfma_f32_16x16x32_bf16 v[88:91], v[52:55], v[204:207], v[88:91]
    v_mfma_f32_16x16x32_bf16 v[92:95], v[52:55], v[196:199], v[92:95]
    v_mfma_f32_16x16x32_bf16 v[88:91], v[56:59], v[192:195], v[88:91]
    v_mfma_f32_16x16x32_bf16 v[92:95], v[56:59], v[208:211], v[92:95]
    buffer_load_dwordx4 v12, s[8:11], s72 offen lds
    s_add_u32 m0, m0, s74
    s_sub_u32 s72, s72, s75
    v_mfma_f32_16x16x32_bf16 v[88:91], v[60:63], v[196:199], v[88:91]
    v_mfma_f32_16x16x32_bf16 v[92:95], v[60:63], v[212:215], v[92:95]
    s_waitcnt lgkmcnt(0)
    v_mfma_f32_16x16x32_bf16 v[96:99], v[64:67], v[200:203], 0
    v_mfma_f32_16x16x32_bf16 v[100:103], v[64:67], v[192:195], 0
    buffer_load_dwordx4 v12, s[8:11], s72 offen lds
    s_add_u32 m0, m0, s74
    s_sub_u32 s72, s72, s75
    v_mfma_f32_16x16x32_bf16 v[96:99], v[68:71], v[204:207], v[96:99]
    v_mfma_f32_16x16x32_bf16 v[100:103], v[68:71], v[196:199], v[100:103]
    v_mfma_f32_16x16x32_bf16 v[96:99], v[72:75], v[192:195], v[96:99]
    v_mfma_f32_16x16x32_bf16 v[100:103], v[72:75], v[208:211], v[100:103]
    buffer_load_dwordx4 v12, s[8:11], s72 offen lds
    v_mfma_f32_16x16x32_bf16 v[96:99], v[76:79], v[196:199], v[96:99]
    v_mfma_f32_16x16x32_bf16 v[100:103], v[76:79], v[212:215], v[100:103]
L_s1_done:
    v_cvt_pk_bf16_f32 v104, v80, v81
    v_cvt_pk_bf16_f32 v105, v82, v83
    v_cvt_pk_bf16_f32 v106, v84, v85
    v_cvt_pk_bf16_f32 v107, v86, v87
    buffer_store_dwordx4 v[104:107], v4, s[32:35], s54 offen offset:0 sc1
    v_cvt_pk_bf16_f32 v108, v88, v89
    v_cvt_pk_bf16_f32 v109, v90, v91
    v_cvt_pk_bf16_f32 v110, v92, v93
    v_cvt_pk_bf16_f32 v111, v94, v95
    buffer_store_dwordx4 v[108:111], v4, s[32:35], s54 offen offset:128 sc1
    s_bitcmp1_b32 s46, 1
    s_cbranch_scc1 L_z3
    v_cvt_pk_bf16_f32 v112, v96, v97
    v_cvt_pk_bf16_f32 v113, v98, v99
    v_cvt_pk_bf16_f32 v114, v100, v101
    v_cvt_pk_bf16_f32 v115, v102, v103
    buffer_store_dwordx4 v[112:115], v4, s[32:35], s54 offen offset:256 sc1
L_z3:
    v_accvgpr_read_b32 v14, a196
    v_accvgpr_read_b32 v15, a197
    v_accvgpr_read_b32 v248, a198
    s_add_u32 m0, s62, 81920
    v_accvgpr_read_b32 v249, a199
    v_accvgpr_read_b32 v16, a200
    v_accvgpr_read_b32 v17, a201
    v_accvgpr_read_b32 v18, a202
    s_mov_b32 s64, s90
    s_mul_i32 s63, s92, 0
    s_add_u32 s63, s63, s91
    s_add_u32 s63, s63, s64
    buffer_load_dwordx4 v241, s[16:19], s64 offen lds
    s_waitcnt vmcnt(14)
    ds_read_b128 v[192:195], v16 offset:0
    ds_read_b128 v[196:199], v17 offset:0
    ds_read_u16 v8, v18 offset:0
    ds_read_b128 v[24:27], v16 offset:1024
    ds_read_b128 v[28:31], v17 offset:1024
    ds_read_u16 v19, v18 offset:1024
    s_waitcnt lgkmcnt(3)
    v_cndmask_b32 v8, v8, v244, s[86:87]
    v_lshlrev_b32 v32, 16, v192
    v_and_b32 v36, s58, v192
    v_lshlrev_b32 v33, 16, v193
    v_and_b32 v37, s58, v193
    v_lshlrev_b32 v34, 16, v194
    v_and_b32 v38, s58, v194
    v_lshlrev_b32 v35, 16, v195
    v_and_b32 v39, s58, v195
    v_lshlrev_b32 v112, 16, v8
    v_lshlrev_b32 v113, 16, v199
    v_lshlrev_b32 v114, 16, v198
    v_lshlrev_b32 v115, 16, v197
    v_and_b32 v116, s58, v199
    s_add_u32 m0, s62, 82944
    v_and_b32 v117, s58, v198
    v_and_b32 v118, s58, v197
    v_and_b32 v119, s58, v196
    v_lshlrev_b32 v4, 16, v242
    v_mov_b32 v244, v112
    v_cndmask_b32 v32, v32, v4, s[94:95]
    v_pk_add_f32 v[112:113], v[112:113], v[32:33] neg_lo:[0,1] neg_hi:[0,1]
    v_pk_add_f32 v[114:115], v[114:115], v[34:35] neg_lo:[0,1] neg_hi:[0,1]
    buffer_load_dwordx4 v239, s[16:19], s63 offen lds
    v_pk_add_f32 v[116:117], v[116:117], v[36:37] neg_lo:[0,1] neg_hi:[0,1]
    v_pk_add_f32 v[118:119], v[118:119], v[38:39] neg_lo:[0,1] neg_hi:[0,1]
    ds_read_b128 v[192:195], v16 offset:2048
    ds_read_b128 v[196:199], v17 offset:2048
    ds_read_u16 v8, v18 offset:2048
    s_waitcnt lgkmcnt(3)
    v_lshlrev_b32 v40, 16, v24
    v_and_b32 v44, s58, v24
    v_lshlrev_b32 v41, 16, v25
    v_and_b32 v45, s58, v25
    v_lshlrev_b32 v42, 16, v26
    v_and_b32 v46, s58, v26
    v_lshlrev_b32 v43, 16, v27
    v_and_b32 v47, s58, v27
    v_lshlrev_b32 v120, 16, v19
    v_lshlrev_b32 v121, 16, v31
    v_lshlrev_b32 v122, 16, v30
    v_lshlrev_b32 v123, 16, v29
    v_and_b32 v124, s58, v31
    v_and_b32 v125, s58, v30
    v_and_b32 v126, s58, v29
    v_and_b32 v127, s58, v28
    s_add_u32 m0, s62, 83968
    v_pk_add_f32 v[120:121], v[120:121], v[40:41] neg_lo:[0,1] neg_hi:[0,1]
    v_pk_add_f32 v[122:123], v[122:123], v[42:43] neg_lo:[0,1] neg_hi:[0,1]
    v_pk_add_f32 v[124:125], v[124:125], v[44:45] neg_lo:[0,1] neg_hi:[0,1]
    v_pk_add_f32 v[126:127], v[126:127], v[46:47] neg_lo:[0,1] neg_hi:[0,1]
    ds_read_b128 v[24:27], v16 offset:3072
    ds_read_b128 v[28:31], v17 offset:3072
    ds_read_u16 v19, v18 offset:3072
    s_waitcnt lgkmcnt(3)
    buffer_load_dwordx4 v240, s[16:19], s63 offen lds
    v_lshlrev_b32 v48, 16, v192
    v_and_b32 v52, s58, v192
    v_lshlrev_b32 v49, 16, v193
    v_and_b32 v53, s58, v193
    v_lshlrev_b32 v50, 16, v194
    v_and_b32 v54, s58, v194
    v_lshlrev_b32 v51, 16, v195
    v_and_b32 v55, s58, v195
    v_lshlrev_b32 v128, 16, v8
    v_lshlrev_b32 v129, 16, v199
    v_lshlrev_b32 v130, 16, v198
    v_lshlrev_b32 v131, 16, v197
    v_and_b32 v132, s58, v199
    v_and_b32 v133, s58, v198
    v_and_b32 v134, s58, v197
    v_and_b32 v135, s58, v196
    v_pk_add_f32 v[128:129], v[128:129], v[48:49] neg_lo:[0,1] neg_hi:[0,1]
    v_pk_add_f32 v[130:131], v[130:131], v[50:51] neg_lo:[0,1] neg_hi:[0,1]
    v_pk_add_f32 v[132:133], v[132:133], v[52:53] neg_lo:[0,1] neg_hi:[0,1]
    v_pk_add_f32 v[134:135], v[134:135], v[54:55] neg_lo:[0,1] neg_hi:[0,1]
    ds_read_b128 v[192:195], v16 offset:4096
    ds_read_b128 v[196:199], v17 offset:4096
    s_add_u32 m0, s62, 88064
    s_add_u32 s63, s63, s92
    ds_read_u16 v8, v18 offset:4096
    s_waitcnt lgkmcnt(3)
    v_lshlrev_b32 v56, 16, v24
    v_and_b32 v60, s58, v24
    v_lshlrev_b32 v57, 16, v25
    v_and_b32 v61, s58, v25
    v_lshlrev_b32 v58, 16, v26
    v_and_b32 v62, s58, v26
    buffer_load_dwordx4 v238, s[16:19], s63 offen lds
    v_lshlrev_b32 v59, 16, v27
    v_and_b32 v63, s58, v27
    v_lshlrev_b32 v136, 16, v19
    v_lshlrev_b32 v137, 16, v31
    v_lshlrev_b32 v138, 16, v30
    v_lshlrev_b32 v139, 16, v29
    v_and_b32 v140, s58, v31
    v_and_b32 v141, s58, v30
    v_and_b32 v142, s58, v29
    v_and_b32 v143, s58, v28
    v_pk_add_f32 v[136:137], v[136:137], v[56:57] neg_lo:[0,1] neg_hi:[0,1]
    v_pk_add_f32 v[138:139], v[138:139], v[58:59] neg_lo:[0,1] neg_hi:[0,1]
    v_pk_add_f32 v[140:141], v[140:141], v[60:61] neg_lo:[0,1] neg_hi:[0,1]
    v_pk_add_f32 v[142:143], v[142:143], v[62:63] neg_lo:[0,1] neg_hi:[0,1]
    s_waitcnt vmcnt(6)
    ds_read_b128 v[24:27], v16 offset:5120
    ds_read_b128 v[28:31], v17 offset:5120
    ds_read_u16 v19, v18 offset:5120
    s_waitcnt lgkmcnt(3)
    v_lshlrev_b32 v64, 16, v192
    v_and_b32 v68, s58, v192
    v_lshlrev_b32 v65, 16, v193
    v_and_b32 v69, s58, v193
    v_lshlrev_b32 v66, 16, v194
    v_and_b32 v70, s58, v194
    v_lshlrev_b32 v67, 16, v195
    v_and_b32 v71, s58, v195
    v_lshlrev_b32 v144, 16, v8
    v_lshlrev_b32 v145, 16, v199
    v_lshlrev_b32 v146, 16, v198
    v_lshlrev_b32 v147, 16, v197
    v_and_b32 v148, s58, v199
    v_and_b32 v149, s58, v198
    v_and_b32 v150, s58, v197
    v_and_b32 v151, s58, v196
    v_pk_add_f32 v[144:145], v[144:145], v[64:65] neg_lo:[0,1] neg_hi:[0,1]
    v_pk_add_f32 v[146:147], v[146:147], v[66:67] neg_lo:[0,1] neg_hi:[0,1]
    v_pk_add_f32 v[148:149], v[148:149], v[68:69] neg_lo:[0,1] neg_hi:[0,1]
    v_pk_add_f32 v[150:151], v[150:151], v[70:71] neg_lo:[0,1] neg_hi:[0,1]
    ds_read_b128 v[192:195], v16 offset:6144
    ds_read_b128 v[196:199], v17 offset:6144
    ds_read_u16 v8, v18 offset:6144
    s_waitcnt lgkmcnt(3)
    v_cndmask_b32 v19, v19, v245, s[86:87]
    v_lshlrev_b32 v72, 16, v24
    v_and_b32 v76, s58, v24
    v_lshlrev_b32 v73, 16, v25
    v_and_b32 v77, s58, v25
    v_lshlrev_b32 v74, 16, v26
    v_and_b32 v78, s58, v26
    v_lshlrev_b32 v75, 16, v27
    v_and_b32 v79, s58, v27
    v_lshlrev_b32 v152, 16, v19
    v_lshlrev_b32 v153, 16, v31
    v_lshlrev_b32 v154, 16, v30
    v_lshlrev_b32 v155, 16, v29
    v_and_b32 v156, s58, v31
    v_and_b32 v157, s58, v30
    v_and_b32 v158, s58, v29
    v_and_b32 v159, s58, v28
    v_lshlrev_b32 v4, 16, v243
    v_mov_b32 v245, v152
    v_cndmask_b32 v72, v72, v4, s[94:95]
    v_pk_add_f32 v[152:153], v[152:153], v[72:73] neg_lo:[0,1] neg_hi:[0,1]
    v_pk_add_f32 v[154:155], v[154:155], v[74:75] neg_lo:[0,1] neg_hi:[0,1]
    v_pk_add_f32 v[156:157], v[156:157], v[76:77] neg_lo:[0,1] neg_hi:[0,1]
    v_pk_add_f32 v[158:159], v[158:159], v[78:79] neg_lo:[0,1] neg_hi:[0,1]
    ds_read_b128 v[24:27], v16 offset:7168
    ds_read_b128 v[28:31], v17 offset:7168
    ds_read_u16 v19, v18 offset:7168
    s_waitcnt lgkmcnt(3)
    v_lshlrev_b32 v80, 16, v192
    v_and_b32 v84, s58, v192
    v_lshlrev_b32 v81, 16, v193
    v_and_b32 v85, s58, v193
    v_lshlrev_b32 v82, 16, v194
    v_and_b32 v86, s58, v194
    v_lshlrev_b32 v83, 16, v195
    v_and_b32 v87, s58, v195
    v_lshlrev_b32 v160, 16, v8
    v_lshlrev_b32 v161, 16, v199
    v_lshlrev_b32 v162, 16, v198
    v_lshlrev_b32 v163, 16, v197
    v_and_b32 v164, s58, v199
    v_and_b32 v165, s58, v198
    v_and_b32 v166, s58, v197
    v_and_b32 v167, s58, v196
    v_pk_add_f32 v[160:161], v[160:161], v[80:81] neg_lo:[0,1] neg_hi:[0,1]
    v_pk_add_f32 v[162:163], v[162:163], v[82:83] neg_lo:[0,1] neg_hi:[0,1]
    v_pk_add_f32 v[164:165], v[164:165], v[84:85] neg_lo:[0,1] neg_hi:[0,1]
    v_pk_add_f32 v[166:167], v[166:167], v[86:87] neg_lo:[0,1] neg_hi:[0,1]
    s_waitcnt vmcnt(4)
    v_readfirstlane_b32 s49, v246
    s_mov_b32 s85, 0x4000
L_nonce_chk:
    s_cmp_lg_u32 s49, 0
    s_cbranch_scc1 L_nonce_ok
    v_mov_b32 v4, 0
    buffer_load_dword v246, v4, s[36:39], 0 offen sc1
    s_waitcnt vmcnt(0)
    v_readfirstlane_b32 s49, v246
    s_sub_u32 s85, s85, 1
    s_cmp_lg_u32 s85, 0
    s_cbranch_scc1 L_nonce_chk
L_nonce_ok:
    s_barrier
    s_cmp_lg_u32 s44, 0
    s_cbranch_scc1 L_fa_skip
    s_lshr_b32 s98, s2, 2
    s_lshl_b32 s98, s98, 7
    s_and_b32 s99, s2, 3
    s_lshl_b32 s99, s99, 2
    s_add_u32 s98, s98, s99
    s_add_u32 s98, s98, 0xd00000
    v_mov_b32 v4, s49
    v_mov_b32 v5, 0
    s_mov_b64 exec, 1
    buffer_store_dword v4, v5, s[32:35], s98 offen sc1
    s_mov_b64 exec, -1
L_fa_skip:
    s_add_u32 m0, s62, 89088
    s_nop 0
    buffer_load_dwordx4 v239, s[16:19], s63 offen lds
    s_add_u32 m0, s62, 90112
    ds_read_b128 v[192:195], v16 offset:8192
    ds_read_b128 v[196:199], v17 offset:8192
    ds_read_u16 v8, v18 offset:8192
    s_waitcnt lgkmcnt(3)
    v_lshlrev_b32 v88, 16, v24
    v_and_b32 v92, s58, v24
    v_lshlrev_b32 v89, 16, v25
    v_and_b32 v93, s58, v25
    buffer_load_dwordx4 v240, s[16:19], s63 offen lds
    s_add_u32 m0, s62, 94208
    s_add_u32 s63, s63, s92
    v_lshlrev_b32 v90, 16, v26
    v_and_b32 v94, s58, v26
    v_lshlrev_b32 v91, 16, v27
    v_and_b32 v95, s58, v27
    v_lshlrev_b32 v168, 16, v19
    v_lshlrev_b32 v169, 16, v31
    v_lshlrev_b32 v170, 16, v30
    v_lshlrev_b32 v171, 16, v29
    buffer_load_dwordx4 v238, s[16:19], s63 offen lds
    s_add_u32 m0, s62, 95232
    v_and_b32 v172, s58, v31
    v_and_b32 v173, s58, v30
    v_and_b32 v174, s58, v29
    v_and_b32 v175, s58, v28
    v_pk_add_f32 v[168:169], v[168:169], v[88:89] neg_lo:[0,1] neg_hi:[0,1]
    v_pk_add_f32 v[170:171], v[170:171], v[90:91] neg_lo:[0,1] neg_hi:[0,1]
    v_pk_add_f32 v[172:173], v[172:173], v[92:93] neg_lo:[0,1] neg_hi:[0,1]
    v_pk_add_f32 v[174:175], v[174:175], v[94:95] neg_lo:[0,1] neg_hi:[0,1]
    buffer_load_dwordx4 v239, s[16:19], s63 offen lds
    s_add_u32 m0, s62, 96256
    ds_read_b128 v[24:27], v16 offset:9216
    ds_read_b128 v[28:31], v17 offset:9216
    ds_read_u16 v19, v18 offset:9216
    s_waitcnt lgkmcnt(3)
    v_lshlrev_b32 v96, 16, v192
    v_and_b32 v100, s58, v192
    v_lshlrev_b32 v97, 16, v193
    v_and_b32 v101, s58, v193
    buffer_load_dwordx4 v240, s[16:19], s63 offen lds
    s_add_u32 m0, s62, 100352
    s_add_u32 s63, s63, s92
    v_lshlrev_b32 v98, 16, v194
    v_and_b32 v102, s58, v194
    v_lshlrev_b32 v99, 16, v195
    v_and_b32 v103, s58, v195
    v_lshlrev_b32 v176, 16, v8
    v_lshlrev_b32 v177, 16, v199
    v_lshlrev_b32 v178, 16, v198
    v_lshlrev_b32 v179, 16, v197
    buffer_load_dwordx4 v238, s[16:19], s63 offen lds
    s_add_u32 m0, s62, 101376
    v_and_b32 v180, s58, v199
    v_and_b32 v181, s58, v198
    v_and_b32 v182, s58, v197
    v_and_b32 v183, s58, v196
    v_pk_add_f32 v[176:177], v[176:177], v[96:97] neg_lo:[0,1] neg_hi:[0,1]
    v_pk_add_f32 v[178:179], v[178:179], v[98:99] neg_lo:[0,1] neg_hi:[0,1]
    v_pk_add_f32 v[180:181], v[180:181], v[100:101] neg_lo:[0,1] neg_hi:[0,1]
    v_pk_add_f32 v[182:183], v[182:183], v[102:103] neg_lo:[0,1] neg_hi:[0,1]
    buffer_load_dwordx4 v239, s[16:19], s63 offen lds
    s_add_u32 m0, s62, 102400
    s_waitcnt lgkmcnt(0)
    v_lshlrev_b32 v104, 16, v24
    v_and_b32 v108, s58, v24
    v_lshlrev_b32 v105, 16, v25
    v_and_b32 v109, s58, v25
    v_lshlrev_b32 v106, 16, v26
    v_and_b32 v110, s58, v26
    v_lshlrev_b32 v107, 16, v27
    buffer_load_dwordx4 v240, s[16:19], s63 offen lds
    s_add_u32 m0, s62, 106496
    s_add_u32 s63, s63, s92
    v_and_b32 v111, s58, v27
    v_lshlrev_b32 v184, 16, v19
    v_lshlrev_b32 v185, 16, v31
    v_lshlrev_b32 v186, 16, v30
    v_lshlrev_b32 v187, 16, v29
    v_and_b32 v188, s58, v31
    v_and_b32 v189, s58, v30
    v_and_b32 v190, s58, v29
    buffer_load_dwordx4 v238, s[16:19], s63 offen lds
    s_add_u32 m0, s62, 107520
    v_and_b32 v191, s58, v28
    v_pk_add_f32 v[184:185], v[184:185], v[104:105] neg_lo:[0,1] neg_hi:[0,1]
    v_pk_add_f32 v[186:187], v[186:187], v[106:107] neg_lo:[0,1] neg_hi:[0,1]
    v_pk_add_f32 v[188:189], v[188:189], v[108:109] neg_lo:[0,1] neg_hi:[0,1]
    v_pk_add_f32 v[190:191], v[190:191], v[110:111] neg_lo:[0,1] neg_hi:[0,1]
    buffer_load_dwordx4 v239, s[16:19], s63 offen lds
    s_add_u32 m0, s62, 108544
    s_nop 0
    buffer_load_dwordx4 v240, s[16:19], s63 offen lds
    s_barrier
    s_mov_b32 s64, s90
    s_mul_i32 s63, s92, 5
    s_add_u32 s63, s63, s91
    s_add_u32 s63, s63, s64
    s_add_u32 m0, s62, 0
    s_nop 0
    buffer_load_dwordx4 v238, s[16:19], s63 offen lds
    s_add_u32 m0, s62, 1024
    v_accvgpr_read_b32 v212, a203
    v_accvgpr_read_b32 v214, a204
    buffer_load_dwordx4 v239, s[16:19], s63 offen lds
    s_add_u32 m0, s62, 2048
    v_accvgpr_read_b32 v215, a205
    v_accvgpr_read_b32 v234, a206
    buffer_load_dwordx4 v240, s[16:19], s63 offen lds
    s_add_u32 m0, s62, 6144
    s_add_u32 s63, s63, s92
    v_accvgpr_read_b32 v235, a207
    v_accvgpr_read_b32 v213, a208
    buffer_load_dwordx4 v238, s[16:19], s63 offen lds
    s_add_u32 m0, s62, 7168
    v_accvgpr_read_b32 v232, a209
    v_accvgpr_read_b32 v233, a210
    buffer_load_dwordx4 v239, s[16:19], s63 offen lds
    s_add_u32 m0, s62, 8192
    v_accvgpr_read_b32 v208, a211
    v_accvgpr_read_b32 v209, a212
    buffer_load_dwordx4 v240, s[16:19], s63 offen lds
    s_add_u32 m0, s62, 12288
    s_add_u32 s63, s63, s92
    v_accvgpr_read_b32 v210, a213
    v_accvgpr_read_b32 v211, a214
    buffer_load_dwordx4 v238, s[16:19], s63 offen lds
    s_add_u32 m0, s62, 13312
    v_accvgpr_read_b32 v204, a215
    v_accvgpr_read_b32 v205, a216
    buffer_load_dwordx4 v239, s[16:19], s63 offen lds
    s_add_u32 m0, s62, 14336
    v_accvgpr_read_b32 v206, a217
    v_accvgpr_read_b32 v207, a218
    buffer_load_dwordx4 v240, s[16:19], s63 offen lds
    s_add_u32 m0, s62, 18432
    s_add_u32 s63, s63, s92
    v_accvgpr_read_b32 v200, a219
    v_accvgpr_read_b32 v201, a220
    buffer_load_dwordx4 v238, s[16:19], s63 offen lds
    v_accvgpr_read_b32 v202, a221
    v_accvgpr_read_b32 v203, a222
    v_accvgpr_read_b32 v254, a223
    v_accvgpr_read_b32 v251, a224
    v_accvgpr_read_b32 v252, a225
    v_accvgpr_read_b32 v253, a226
    v_accvgpr_read_b32 v236, a227
    v_accvgpr_read_b32 v237, a228
    s_waitcnt vmcnt(10)
    s_barrier
    v_lshlrev_b32 v4, 7, v0
    s_mov_b32 s85, 0xd00000
    s_cmp_lg_u32 s44, 0
    s_cbranch_scc1 L_pa0
    buffer_load_dwordx4 v[24:27], v4, s[32:35], s85 offen sc1
L_pa0:
    ds_read_b64_tr_b16 a[0:1], v248 offset:0
    ds_read_b64_tr_b16 a[2:3], v248 offset:768
    ds_read_b64_tr_b16 a[4:5], v249 offset:32
    ds_read_b64_tr_b16 a[6:7], v249 offset:800
    s_add_u32 m0, s62, 19456
    ds_read_b64_tr_b16 a[8:9], v248 offset:64
    ds_read_b64_tr_b16 a[10:11], v248 offset:832
    ds_read_b64_tr_b16 a[12:13], v248 offset:6144
    ds_read_b64_tr_b16 a[14:15], v248 offset:6912
    ds_read_b64_tr_b16 a[16:17], v249 offset:6176
    ds_read_b64_tr_b16 a[18:19], v249 offset:6944
    ds_read_b64_tr_b16 a[20:21], v248 offset:6208
    ds_read_b64_tr_b16 a[22:23], v248 offset:6976
    buffer_load_dwordx4 v239, s[16:19], s63 offen lds
    s_add_u32 m0, s62, 20480
    s_nop 0
    buffer_load_dwordx4 v240, s[16:19], s63 offen lds
    s_add_u32 m0, s62, 24576
    s_add_u32 s63, s63, s92
    buffer_load_dwordx4 v238, s[16:19], s63 offen lds
    s_waitcnt lgkmcnt(6)
    v_mfma_f32_16x16x32_bf16 a[184:187], a[0:3], v[20:23], 0
    s_add_u32 m0, s62, 25600
    ds_read_b64_tr_b16 a[24:25], v248 offset:12288
    ds_read_b64_tr_b16 a[26:27], v248 offset:13056
    v_mfma_f32_16x16x32_bf16 a[188:191], a[4:7], v[20:23], 0
    ds_read_b64_tr_b16 a[28:29], v249 offset:12320
    ds_read_b64_tr_b16 a[30:31], v249 offset:13088
    v_mfma_f32_16x16x32_bf16 a[192:195], a[8:11], v[20:23], 0
    ds_read_b64_tr_b16 a[32:33], v248 offset:12352
    ds_read_b64_tr_b16 a[34:35], v248 offset:13120
    buffer_load_dwordx4 v239, s[16:19], s63 offen lds
    s_add_u32 m0, s62, 26624
    s_nop 0
    buffer_load_dwordx4 v240, s[16:19], s63 offen lds
    s_waitcnt lgkmcnt(6)
    v_mfma_f32_16x16x32_bf16 a[184:187], a[12:15], v[20:23], a[184:187]
    ds_read_b64_tr_b16 a[36:37], v248 offset:18432
    ds_read_b64_tr_b16 a[38:39], v248 offset:19200
    v_mfma_f32_16x16x32_bf16 a[188:191], a[16:19], v[20:23], a[188:191]
    ds_read_b64_tr_b16 a[40:41], v249 offset:18464
    ds_read_b64_tr_b16 a[42:43], v249 offset:19232
    v_mfma_f32_16x16x32_bf16 a[192:195], a[20:23], v[20:23], a[192:195]
    ds_read_b64_tr_b16 a[44:45], v248 offset:18496
    ds_read_b64_tr_b16 a[46:47], v248 offset:19264
    s_waitcnt lgkmcnt(6)
    v_mfma_f32_16x16x32_bf16 a[184:187], a[24:27], v[20:23], a[184:187]
    ds_read_b64_tr_b16 a[48:49], v248 offset:24576
    ds_read_b64_tr_b16 a[50:51], v248 offset:25344
    v_mfma_f32_16x16x32_bf16 a[188:191], a[28:31], v[20:23], a[188:191]
    ds_read_b64_tr_b16 a[52:53], v249 offset:24608
    ds_read_b64_tr_b16 a[54:55], v249 offset:25376
    v_mfma_f32_16x16x32_bf16 a[192:195], a[32:35], v[20:23], a[192:195]
    ds_read_b64_tr_b16 a[56:57], v248 offset:24640
    ds_read_b64_tr_b16 a[58:59], v248 offset:25408
    s_waitcnt lgkmcnt(6)
    v_mfma_f32_16x16x32_bf16 a[184:187], a[36:39], v[20:23], a[184:187]
    v_mfma_f32_16x16x32_bf16 a[188:191], a[40:43], v[20:23], a[188:191]
    v_mfma_f32_16x16x32_bf16 a[192:195], a[44:47], v[20:23], a[192:195]
    s_waitcnt lgkmcnt(0)
    v_mfma_f32_16x16x32_bf16 a[184:187], a[48:51], v[20:23], a[184:187]
    v_mfma_f32_16x16x32_bf16 a[188:191], a[52:55], v[20:23], a[188:191]
    v_mfma_f32_16x16x32_bf16 a[192:195], a[56:59], v[20:23], a[192:195]
    s_cmp_lg_u32 s44, 0
    s_cbranch_scc1 L_pa_skip
    s_mov_b32 s84, 0x4000
    s_waitcnt vmcnt(5)
    s_branch L_pa_chk
L_pa:
    buffer_load_dwordx4 v[24:27], v4, s[32:35], s85 offen sc1
    s_waitcnt vmcnt(0)
L_pa_chk:
    v_xor_b32 v24, s49, v24
    v_xor_b32 v25, s49, v25
    v_xor_b32 v26, s49, v26
    v_xor_b32 v27, s49, v27
    v_or3_b32 v24, v24, v25, v26
    v_or_b32 v24, v24, v27
    v_cmp_ne_u32 vcc, 0, v24
    s_cbranch_vccz L_pa_ok
    s_sleep 2
    s_sub_u32 s84, s84, 1
    s_cmp_lg_u32 s84, 0
    s_cbranch_scc1 L_pa
L_pa_ok:
L_pa_skip:
    s_add_u32 m0, s56, 81920
    s_add_u32 s53, s66, 0
    s_barrier
    buffer_load_dwordx4 v212, s[32:35], s53 offen sc1 lds
    s_add_u32 m0, s56, 82944
    s_add_u32 s53, s66, 10240
    buffer_load_dwordx4 v212, s[32:35], s53 offen sc1 lds
    s_add_u32 m0, s56, 83968
    s_add_u32 s53, s66, 20480
    buffer_load_dwordx4 v212, s[32:35], s53 offen sc1 lds
    s_add_u32 m0, s56, 84992
    s_add_u32 s53, s66, 30720
    buffer_load_dwordx4 v212, s[32:35], s53 offen sc1 lds
    s_add_u32 m0, s56, 86016
    s_add_u32 s53, s66, 128
    buffer_load_dwordx4 v212, s[32:35], s53 offen sc1 lds
    s_add_u32 m0, s56, 87040
    s_add_u32 s53, s66, 10368
    buffer_load_dwordx4 v212, s[32:35], s53 offen sc1 lds
    s_add_u32 m0, s56, 88064
    s_add_u32 s53, s66, 20608
    buffer_load_dwordx4 v212, s[32:35], s53 offen sc1 lds
    s_add_u32 m0, s56, 89088
    s_add_u32 s53, s66, 30848
    buffer_load_dwordx4 v212, s[32:35], s53 offen sc1 lds
    s_waitcnt vmcnt(8)
    s_barrier
    ds_read_b64_tr_b16 a[60:61], v14 offset:0
    ds_read_b64_tr_b16 a[62:63], v14 offset:768
    ds_read_b64_tr_b16 a[64:65], v15 offset:32
    ds_read_b64_tr_b16 a[66:67], v15 offset:800
    ds_read_b64_tr_b16 a[68:69], v14 offset:64
    ds_read_b64_tr_b16 a[70:71], v14 offset:832
    ds_read_b64_tr_b16 a[72:73], v14 offset:6144
    ds_read_b64_tr_b16 a[74:75], v14 offset:6912
    ds_read_b64_tr_b16 a[76:77], v15 offset:6176
    ds_read_b64_tr_b16 a[78:79], v15 offset:6944
    ds_read_b64_tr_b16 a[80:81], v14 offset:6208
    ds_read_b64_tr_b16 a[82:83], v14 offset:6976
    s_waitcnt lgkmcnt(6)
    v_mfma_f32_16x16x32_bf16 a[184:187], a[60:63], v[20:23], a[184:187]
    ds_read_b64_tr_b16 a[84:85], v14 offset:12288
    ds_read_b64_tr_b16 a[86:87], v14 offset:13056
    v_mfma_f32_16x16x32_bf16 a[188:191], a[64:67], v[20:23], a[188:191]
    ds_read_b64_tr_b16 a[88:89], v15 offset:12320
    ds_read_b64_tr_b16 a[90:91], v15 offset:13088
    v_mfma_f32_16x16x32_bf16 a[192:195], a[68:71], v[20:23], a[192:195]
    ds_read_b64_tr_b16 a[92:93], v14 offset:12352
    ds_read_b64_tr_b16 a[94:95], v14 offset:13120
    s_waitcnt lgkmcnt(6)
    v_mfma_f32_16x16x32_bf16 a[184:187], a[72:75], v[20:23], a[184:187]
    ds_read_b64_tr_b16 a[96:97], v14 offset:18432
    ds_read_b64_tr_b16 a[98:99], v14 offset:19200
    v_mfma_f32_16x16x32_bf16 a[188:191], a[76:79], v[20:23], a[188:191]
    ds_read_b64_tr_b16 a[100:101], v15 offset:18464
    ds_read_b64_tr_b16 a[102:103], v15 offset:19232
    v_mfma_f32_16x16x32_bf16 a[192:195], a[80:83], v[20:23], a[192:195]
    ds_read_b64_tr_b16 a[104:105], v14 offset:18496
    ds_read_b64_tr_b16 a[106:107], v14 offset:19264
    s_waitcnt lgkmcnt(6)
    v_mfma_f32_16x16x32_bf16 a[184:187], a[84:87], v[20:23], a[184:187]
    ds_read_b64_tr_b16 a[108:109], v14 offset:24576
    ds_read_b64_tr_b16 a[110:111], v14 offset:25344
    v_mfma_f32_16x16x32_bf16 a[188:191], a[88:91], v[20:23], a[188:191]
    ds_read_b64_tr_b16 a[112:113], v15 offset:24608
    ds_read_b64_tr_b16 a[114:115], v15 offset:25376
    v_mfma_f32_16x16x32_bf16 a[192:195], a[92:95], v[20:23], a[192:195]
    ds_read_b64_tr_b16 a[116:117], v14 offset:24640
    ds_read_b64_tr_b16 a[118:119], v14 offset:25408
    s_waitcnt lgkmcnt(6)
    v_mfma_f32_16x16x32_bf16 a[184:187], a[96:99], v[20:23], a[184:187]
    v_mfma_f32_16x16x32_bf16 a[188:191], a[100:103], v[20:23], a[188:191]
    v_mfma_f32_16x16x32_bf16 a[192:195], a[104:107], v[20:23], a[192:195]
    s_waitcnt lgkmcnt(0)
    v_mfma_f32_16x16x32_bf16 a[184:187], a[108:111], v[20:23], a[184:187]
    v_mfma_f32_16x16x32_bf16 a[188:191], a[112:115], v[20:23], a[188:191]
    v_mfma_f32_16x16x32_bf16 a[192:195], a[116:119], v[20:23], a[192:195]
    s_barrier
    s_waitcnt vmcnt(4)
    ds_read_b64_tr_b16 a[120:121], v214 offset:0
    ds_read_b64_tr_b16 a[122:123], v215 offset:0
    s_add_u32 m0, s56, 90112
    s_add_u32 s53, s66, 256
    ds_read_b64_tr_b16 a[124:125], v214 offset:2048
    ds_read_b64_tr_b16 a[126:127], v215 offset:2048
    ds_read_b64_tr_b16 a[128:129], v234 offset:0
    ds_read_b64_tr_b16 a[130:131], v235 offset:0
    ds_read_b64_tr_b16 a[132:133], v234 offset:2048
    ds_read_b64_tr_b16 a[134:135], v235 offset:2048
    s_waitcnt lgkmcnt(0)
    v_mfma_f32_16x16x32_bf16 v[32:35], a[120:123], v[216:219], v[32:35]
    buffer_load_dwordx4 v212, s[32:35], s53 offen sc1 lds
    s_add_u32 m0, s56, 91136
    s_add_u32 s53, s66, 10496
    v_mfma_f32_16x16x32_bf16 v[36:39], a[128:131], v[216:219], v[36:39]
    buffer_load_dwordx4 v212, s[32:35], s53 offen sc1 lds
    s_add_u32 m0, s56, 92160
    s_add_u32 s53, s66, 20736
    v_mfma_f32_16x16x32_bf16 v[72:75], a[120:123], v[224:227], v[72:75]
    buffer_load_dwordx4 v212, s[32:35], s53 offen sc1 lds
    s_add_u32 m0, s56, 93184
    s_add_u32 s53, s66, 30976
    v_mfma_f32_16x16x32_bf16 v[76:79], a[128:131], v[224:227], v[76:79]
    buffer_load_dwordx4 v212, s[32:35], s53 offen sc1 lds
    s_waitcnt vmcnt(4)
    v_mfma_f32_16x16x32_bf16 v[32:35], a[124:127], v[220:223], v[32:35]
    ds_read_b64_tr_b16 a[136:137], v214 offset:4096
    ds_read_b64_tr_b16 a[138:139], v215 offset:4096
    ds_read_b64_tr_b16 a[140:141], v214 offset:6144
    ds_read_b64_tr_b16 a[142:143], v215 offset:6144
    v_mfma_f32_16x16x32_bf16 v[36:39], a[132:135], v[220:223], v[36:39]
    s_add_u32 m0, s56, 94208
    s_add_u32 s53, s66, 384
    ds_read_b64_tr_b16 a[144:145], v234 offset:4096
    ds_read_b64_tr_b16 a[146:147], v235 offset:4096
    ds_read_b64_tr_b16 a[148:149], v234 offset:6144
    ds_read_b64_tr_b16 a[150:151], v235 offset:6144
    v_mfma_f32_16x16x32_bf16 v[72:75], a[124:127], v[228:231], v[72:75]
    v_mfma_f32_16x16x32_bf16 v[76:79], a[132:135], v[228:231], v[76:79]
    s_waitcnt lgkmcnt(0)
    v_mfma_f32_16x16x32_bf16 v[40:43], a[136:139], v[216:219], v[40:43]
    buffer_load_dwordx4 v212, s[32:35], s53 offen sc1 lds
    s_add_u32 m0, s56, 95232
    s_add_u32 s53, s66, 10624
    v_mfma_f32_16x16x32_bf16 v[44:47], a[144:147], v[216:219], v[44:47]
    buffer_load_dwordx4 v212, s[32:35], s53 offen sc1 lds
    s_add_u32 m0, s56, 96256
    s_add_u32 s53, s66, 20864
    v_mfma_f32_16x16x32_bf16 v[80:83], a[136:139], v[224:227], v[80:83]
    buffer_load_dwordx4 v212, s[32:35], s53 offen sc1 lds
    s_add_u32 m0, s56, 97280
    s_add_u32 s53, s66, 31104
    v_mfma_f32_16x16x32_bf16 v[84:87], a[144:147], v[224:227], v[84:87]
    buffer_load_dwordx4 v212, s[32:35], s53 offen sc1 lds
    s_waitcnt vmcnt(4)
    v_mfma_f32_16x16x32_bf16 v[40:43], a[140:143], v[220:223], v[40:43]
    ds_read_b64_tr_b16 a[120:121], v214 offset:8192
    ds_read_b64_tr_b16 a[122:123], v215 offset:8192
    ds_read_b64_tr_b16 a[124:125], v214 offset:10240
    ds_read_b64_tr_b16 a[126:127], v215 offset:10240
    v_mfma_f32_16x16x32_bf16 v[44:47], a[148:151], v[220:223], v[44:47]
    ds_read_b64_tr_b16 a[128:129], v234 offset:8192
    ds_read_b64_tr_b16 a[130:131], v235 offset:8192
    ds_read_b64_tr_b16 a[132:133], v234 offset:10240
    ds_read_b64_tr_b16 a[134:135], v235 offset:10240
    v_mfma_f32_16x16x32_bf16 v[80:83], a[140:143], v[228:231], v[80:83]
    v_add_f32 v112, v112, v32
    v_add_f32 v113, v113, v33
    v_add_f32 v114, v114, v34
    v_add_f32 v115, v115, v35
    v_mfma_f32_16x16x32_bf16 v[84:87], a[148:151], v[228:231], v[84:87]
    v_add_f32 v116, v116, v36
    v_add_f32 v117, v117, v37
    v_add_f32 v118, v118, v38
    v_add_f32 v119, v119, v39
    v_cndmask_b32 v112, v112, v244, s[94:95]
    v_cvt_pk_bf16_f32 v32, v32, v36
    v_cvt_pk_bf16_f32 v33, v33, v37
    v_cvt_pk_bf16_f32 v34, v34, v38
    v_cvt_pk_bf16_f32 v35, v35, v39
    ds_write_b128 v213, v[32:35] offset:0
    v_cvt_pk_bf16_f32 v112, v112, v116
    v_cvt_pk_bf16_f32 v113, v113, v117
    v_cvt_pk_bf16_f32 v114, v114, v118
    v_cvt_pk_bf16_f32 v115, v115, v119
    ds_write_b128 v232, v[112:115] offset:0
    v_add_f32 v152, v152, v72
    v_add_f32 v153, v153, v73
    v_add_f32 v154, v154, v74
    v_add_f32 v155, v155, v75
    v_add_f32 v156, v156, v76
    v_add_f32 v157, v157, v77
    v_add_f32 v158, v158, v78
    v_add_f32 v159, v159, v79
    v_cndmask_b32 v152, v152, v245, s[94:95]
    v_cvt_pk_bf16_f32 v72, v72, v76
    v_cvt_pk_bf16_f32 v73, v73, v77
    v_cvt_pk_bf16_f32 v74, v74, v78
    v_cvt_pk_bf16_f32 v75, v75, v79
    s_add_u32 m0, s56, 98304
    s_add_u32 s53, s66, 512
    ds_write_b128 v213, v[72:75] offset:20480
    v_cvt_pk_bf16_f32 v152, v152, v156
    v_cvt_pk_bf16_f32 v153, v153, v157
    v_cvt_pk_bf16_f32 v154, v154, v158
    v_cvt_pk_bf16_f32 v155, v155, v159
    ds_write_b128 v233, v[152:155] offset:0
    s_waitcnt lgkmcnt(4)
    v_mfma_f32_16x16x32_bf16 v[48:51], a[120:123], v[216:219], v[48:51]
    buffer_load_dwordx4 v212, s[32:35], s53 offen sc1 lds
    s_add_u32 m0, s56, 99328
    s_add_u32 s53, s66, 10752
    v_mfma_f32_16x16x32_bf16 v[52:55], a[128:131], v[216:219], v[52:55]
    buffer_load_dwordx4 v212, s[32:35], s53 offen sc1 lds
    s_add_u32 m0, s56, 100352
    s_add_u32 s53, s66, 20992
    v_mfma_f32_16x16x32_bf16 v[88:91], a[120:123], v[224:227], v[88:91]
    buffer_load_dwordx4 v212, s[32:35], s53 offen sc1 lds
    s_add_u32 m0, s56, 101376
    s_add_u32 s53, s66, 31232
    v_mfma_f32_16x16x32_bf16 v[92:95], a[128:131], v[224:227], v[92:95]
    buffer_load_dwordx4 v212, s[32:35], s53 offen sc1 lds
    s_waitcnt vmcnt(4)
    v_mfma_f32_16x16x32_bf16 v[48:51], a[124:127], v[220:223], v[48:51]
    ds_read_b64_tr_b16 a[136:137], v214 offset:12288
    ds_read_b64_tr_b16 a[138:139], v215 offset:12288
    ds_read_b64_tr_b16 a[140:141], v214 offset:14336
    ds_read_b64_tr_b16 a[142:143], v215 offset:14336
    v_mfma_f32_16x16x32_bf16 v[52:55], a[132:135], v[220:223], v[52:55]
    ds_read_b64_tr_b16 a[144:145], v234 offset:12288
    ds_read_b64_tr_b16 a[146:147], v235 offset:12288
    ds_read_b64_tr_b16 a[148:149], v234 offset:14336
    ds_read_b64_tr_b16 a[150:151], v235 offset:14336
    v_mfma_f32_16x16x32_bf16 v[88:91], a[124:127], v[228:231], v[88:91]
    v_add_f32 v120, v120, v40
    v_add_f32 v121, v121, v41
    v_add_f32 v122, v122, v42
    v_add_f32 v123, v123, v43
    v_mfma_f32_16x16x32_bf16 v[92:95], a[132:135], v[228:231], v[92:95]
    v_add_f32 v124, v124, v44
    v_add_f32 v125, v125, v45
    v_add_f32 v126, v126, v46
    v_add_f32 v127, v127, v47
    v_mfma_f32_16x16x32_bf16 a[152:155], v[20:23], v[32:35], 0
    v_cvt_pk_bf16_f32 v40, v40, v44
    v_cvt_pk_bf16_f32 v41, v41, v45
    v_cvt_pk_bf16_f32 v42, v42, v46
    v_cvt_pk_bf16_f32 v43, v43, v47
    v_mfma_f32_16x16x32_bf16 a[156:159], v[32:35], v[32:35], 0
    ds_write_b128 v213, v[40:43] offset:1024
    v_cvt_pk_bf16_f32 v120, v120, v124
    v_cvt_pk_bf16_f32 v121, v121, v125
    v_cvt_pk_bf16_f32 v122, v122, v126
    v_mfma_f32_16x16x32_bf16 a[168:171], v[20:23], v[112:115], 0
    v_cvt_pk_bf16_f32 v123, v123, v127
    ds_write_b128 v232, v[120:123] offset:1024
    v_add_f32 v160, v160, v80
    v_add_f32 v161, v161, v81
    v_mfma_f32_16x16x32_bf16 a[172:175], v[112:115], v[112:115], 0
    v_add_f32 v162, v162, v82
    v_add_f32 v163, v163, v83
    v_add_f32 v164, v164, v84
    v_add_f32 v165, v165, v85
    v_mfma_f32_16x16x32_bf16 a[160:163], v[20:23], v[72:75], 0
    v_add_f32 v166, v166, v86
    v_add_f32 v167, v167, v87
    v_cvt_pk_bf16_f32 v80, v80, v84
    v_cvt_pk_bf16_f32 v81, v81, v85
    v_mfma_f32_16x16x32_bf16 a[164:167], v[72:75], v[72:75], 0
    v_cvt_pk_bf16_f32 v82, v82, v86
    v_cvt_pk_bf16_f32 v83, v83, v87
    ds_write_b128 v213, v[80:83] offset:21504
    v_cvt_pk_bf16_f32 v160, v160, v164
    v_mfma_f32_16x16x32_bf16 a[176:179], v[20:23], v[152:155], 0
    v_cvt_pk_bf16_f32 v161, v161, v165
    v_cvt_pk_bf16_f32 v162, v162, v166
    v_cvt_pk_bf16_f32 v163, v163, v167
    ds_write_b128 v233, v[160:163] offset:1024
    v_mfma_f32_16x16x32_bf16 a[180:183], v[152:155], v[152:155], 0
    s_mov_b64 exec, 0x3fffffff
    buffer_load_dword v247, v250, s[16:19], s71 offen
    s_mov_b64 exec, -1
    s_getpc_b64 s[6:7]
L_sequential_preLN__spectral_fnet__mixer_gmlp__prompt_pc_1:
    s_lshl_b32 s84, s44, 13
    v_lshlrev_b32 v6, 7, v0
    v_add_u32 v6, s84, v6
    v_min_u32 v6, L_end-L_sequential_preLN__spectral_fnet__mixer_gmlp__prompt_pc_1, v6
    global_load_dword v247, v6, s[6:7]
    s_and_b32 s84, s48, 3
    s_lshl_b32 s84, s84, 2
    s_lshl_b32 s85, s50, 4
    s_add_u32 s84, s84, s85
    v_add_u32 v6, s84, v2
    v_mul_i32_i24 v6, s89, v6
    v_add_u32 v6, s88, v6
    v_lshlrev_b32 v6, 12, v6
    v_and_b32 v7, 12, v0
    v_lshl_add_u32 v6, v7, 8, v6
    v_and_b32 v7, 3, v0
    v_lshl_add_u32 v6, v7, 7, v6
    buffer_load_dword v247, v6, s[20:23], 0 offen offset:256
    s_lshr_b32 s84, s2, 3
    s_lshl_b32 s84, s84, 2
    s_add_u32 s84, s84, s44
    s_mul_i32 s84, s84, 7680
    s_and_b32 s85, s48, 4
    s_mul_i32 s85, s85, 160
    s_add_u32 s84, s84, s85
    s_movk_i32 s85, 0x3334
    v_mul_u32_u24 v6, s85, v0
    v_lshrrev_b32 v6, 16, v6
    v_mul_u32_u24 v7, 5, v6
    v_sub_u32 v7, v0, v7
    v_mul_u32_u24 v6, 1280, v6
    v_lshl_add_u32 v6, v7, 7, v6
    s_mov_b64 exec, 0x3fffffff
    buffer_load_dword v247, v6, s[24:27], s84 offen
    s_mov_b64 exec, -1
    s_waitcnt lgkmcnt(4)
    v_mfma_f32_16x16x32_bf16 v[56:59], a[136:139], v[216:219], v[56:59]
    v_mfma_f32_16x16x32_bf16 v[60:63], a[144:147], v[216:219], v[60:63]
    v_mfma_f32_16x16x32_bf16 v[96:99], a[136:139], v[224:227], v[96:99]
    v_mfma_f32_16x16x32_bf16 v[100:103], a[144:147], v[224:227], v[100:103]
    s_waitcnt vmcnt(4)
    v_mfma_f32_16x16x32_bf16 v[56:59], a[140:143], v[220:223], v[56:59]
    ds_read_b64_tr_b16 a[120:121], v214 offset:16384
    ds_read_b64_tr_b16 a[122:123], v215 offset:16384
    ds_read_b64_tr_b16 a[124:125], v214 offset:18432
    ds_read_b64_tr_b16 a[126:127], v215 offset:18432
    v_mfma_f32_16x16x32_bf16 v[60:63], a[148:151], v[220:223], v[60:63]
    ds_read_b64_tr_b16 a[128:129], v234 offset:16384
    ds_read_b64_tr_b16 a[130:131], v235 offset:16384
    ds_read_b64_tr_b16 a[132:133], v234 offset:18432
    ds_read_b64_tr_b16 a[134:135], v235 offset:18432
    v_mfma_f32_16x16x32_bf16 v[96:99], a[140:143], v[228:231], v[96:99]
    v_add_f32 v128, v128, v48
    v_add_f32 v129, v129, v49
    v_add_f32 v130, v130, v50
    v_add_f32 v131, v131, v51
    v_mfma_f32_16x16x32_bf16 v[100:103], a[148:151], v[228:231], v[100:103]
    v_add_f32 v132, v132, v52
    v_add_f32 v133, v133, v53
    v_add_f32 v134, v134, v54
    v_add_f32 v135, v135, v55
    v_mfma_f32_16x16x32_bf16 a[152:155], v[20:23], v[40:43], a[152:155]
    v_cvt_pk_bf16_f32 v48, v48, v52
    v_cvt_pk_bf16_f32 v49, v49, v53
    v_cvt_pk_bf16_f32 v50, v50, v54
    v_cvt_pk_bf16_f32 v51, v51, v55
    v_mfma_f32_16x16x32_bf16 a[156:159], v[40:43], v[40:43], a[156:159]
    ds_write_b128 v213, v[48:51] offset:2048
    v_cvt_pk_bf16_f32 v128, v128, v132
    v_cvt_pk_bf16_f32 v129, v129, v133
    v_cvt_pk_bf16_f32 v130, v130, v134
    v_mfma_f32_16x16x32_bf16 a[168:171], v[20:23], v[120:123], a[168:171]
    v_cvt_pk_bf16_f32 v131, v131, v135
    ds_write_b128 v232, v[128:131] offset:2048
    v_add_f32 v168, v168, v88
    v_add_f32 v169, v169, v89
    v_mfma_f32_16x16x32_bf16 a[172:175], v[120:123], v[120:123], a[172:175]
    v_add_f32 v170, v170, v90
    v_add_f32 v171, v171, v91
    v_add_f32 v172, v172, v92
    v_add_f32 v173, v173, v93
    v_mfma_f32_16x16x32_bf16 a[160:163], v[20:23], v[80:83], a[160:163]
    v_add_f32 v174, v174, v94
    v_add_f32 v175, v175, v95
    v_cvt_pk_bf16_f32 v88, v88, v92
    v_cvt_pk_bf16_f32 v89, v89, v93
    v_mfma_f32_16x16x32_bf16 a[164:167], v[80:83], v[80:83], a[164:167]
    v_cvt_pk_bf16_f32 v90, v90, v94
    v_cvt_pk_bf16_f32 v91, v91, v95
    ds_write_b128 v213, v[88:91] offset:22528
    v_cvt_pk_bf16_f32 v168, v168, v172
    v_mfma_f32_16x16x32_bf16 a[176:179], v[20:23], v[160:163], a[176:179]
    v_cvt_pk_bf16_f32 v169, v169, v173
    v_cvt_pk_bf16_f32 v170, v170, v174
    v_cvt_pk_bf16_f32 v171, v171, v175
    ds_write_b128 v233, v[168:171] offset:2048
    v_mfma_f32_16x16x32_bf16 a[180:183], v[160:163], v[160:163], a[180:183]
    s_waitcnt lgkmcnt(4)
    v_mfma_f32_16x16x32_bf16 v[64:67], a[120:123], v[216:219], v[64:67]
    v_add_f32 v136, v136, v56
    v_add_f32 v137, v137, v57
    v_add_f32 v138, v138, v58
    v_mfma_f32_16x16x32_bf16 v[68:71], a[128:131], v[216:219], v[68:71]
    v_add_f32 v139, v139, v59
    v_add_f32 v140, v140, v60
    v_add_f32 v141, v141, v61
    v_mfma_f32_16x16x32_bf16 v[104:107], a[120:123], v[224:227], v[104:107]
    v_add_f32 v142, v142, v62
    v_add_f32 v143, v143, v63
    v_cvt_pk_bf16_f32 v56, v56, v60
    v_mfma_f32_16x16x32_bf16 v[108:111], a[128:131], v[224:227], v[108:111]
    v_cvt_pk_bf16_f32 v57, v57, v61
    v_cvt_pk_bf16_f32 v58, v58, v62
    v_cvt_pk_bf16_f32 v59, v59, v63
    v_mfma_f32_16x16x32_bf16 v[64:67], a[124:127], v[220:223], v[64:67]
    ds_write_b128 v213, v[56:59] offset:3072
    v_cvt_pk_bf16_f32 v136, v136, v140
    v_cvt_pk_bf16_f32 v137, v137, v141
    v_mfma_f32_16x16x32_bf16 v[68:71], a[132:135], v[220:223], v[68:71]
    v_cvt_pk_bf16_f32 v138, v138, v142
    v_cvt_pk_bf16_f32 v139, v139, v143
    ds_write_b128 v232, v[136:139] offset:3072
    v_mfma_f32_16x16x32_bf16 v[104:107], a[124:127], v[228:231], v[104:107]
    v_add_f32 v176, v176, v96
    v_add_f32 v177, v177, v97
    v_add_f32 v178, v178, v98
    v_mfma_f32_16x16x32_bf16 v[108:111], a[132:135], v[228:231], v[108:111]
    v_add_f32 v179, v179, v99
    v_add_f32 v180, v180, v100
    v_add_f32 v181, v181, v101
    v_mfma_f32_16x16x32_bf16 a[152:155], v[20:23], v[48:51], a[152:155]
    v_add_f32 v182, v182, v102
    v_add_f32 v183, v183, v103
    v_cvt_pk_bf16_f32 v96, v96, v100
    v_mfma_f32_16x16x32_bf16 a[156:159], v[48:51], v[48:51], a[156:159]
    v_cvt_pk_bf16_f32 v97, v97, v101
    v_cvt_pk_bf16_f32 v98, v98, v102
    v_cvt_pk_bf16_f32 v99, v99, v103
    v_mfma_f32_16x16x32_bf16 a[168:171], v[20:23], v[128:131], a[168:171]
    ds_write_b128 v213, v[96:99] offset:23552
    v_cvt_pk_bf16_f32 v176, v176, v180
    v_cvt_pk_bf16_f32 v177, v177, v181
    v_mfma_f32_16x16x32_bf16 a[172:175], v[128:131], v[128:131], a[172:175]
    v_cvt_pk_bf16_f32 v178, v178, v182
    v_cvt_pk_bf16_f32 v179, v179, v183
    ds_write_b128 v233, v[176:179] offset:3072
    v_mfma_f32_16x16x32_bf16 a[160:163], v[20:23], v[88:91], a[160:163]
    v_mfma_f32_16x16x32_bf16 a[164:167], v[88:91], v[88:91], a[164:167]
    v_mfma_f32_16x16x32_bf16 a[176:179], v[20:23], v[168:171], a[176:179]
    v_mfma_f32_16x16x32_bf16 a[180:183], v[168:171], v[168:171], a[180:183]
    s_nop 4
    v_mfma_f32_16x16x32_bf16 a[152:155], v[20:23], v[56:59], a[152:155]
    v_add_f32 v144, v144, v64
    v_add_f32 v145, v145, v65
    v_add_f32 v146, v146, v66
    v_mfma_f32_16x16x32_bf16 a[156:159], v[56:59], v[56:59], a[156:159]
    v_add_f32 v147, v147, v67
    v_add_f32 v148, v148, v68
    v_add_f32 v149, v149, v69
    v_mfma_f32_16x16x32_bf16 a[168:171], v[20:23], v[136:139], a[168:171]
    v_add_f32 v150, v150, v70
    v_add_f32 v151, v151, v71
    v_cvt_pk_bf16_f32 v64, v64, v68
    v_mfma_f32_16x16x32_bf16 a[172:175], v[136:139], v[136:139], a[172:175]
    v_cvt_pk_bf16_f32 v65, v65, v69
    v_cvt_pk_bf16_f32 v66, v66, v70
    v_cvt_pk_bf16_f32 v67, v67, v71
    v_mfma_f32_16x16x32_bf16 a[160:163], v[20:23], v[96:99], a[160:163]
    ds_write_b128 v213, v[64:67] offset:4096
    v_cvt_pk_bf16_f32 v144, v144, v148
    v_cvt_pk_bf16_f32 v145, v145, v149
    v_mfma_f32_16x16x32_bf16 a[164:167], v[96:99], v[96:99], a[164:167]
    v_cvt_pk_bf16_f32 v146, v146, v150
    v_cvt_pk_bf16_f32 v147, v147, v151
    ds_write_b128 v232, v[144:147] offset:4096
    v_mfma_f32_16x16x32_bf16 a[176:179], v[20:23], v[176:179], a[176:179]
    v_add_f32 v184, v184, v104
    v_add_f32 v185, v185, v105
    v_add_f32 v186, v186, v106
    v_mfma_f32_16x16x32_bf16 a[180:183], v[176:179], v[176:179], a[180:183]
    v_add_f32 v187, v187, v107
    v_add_f32 v188, v188, v108
    v_add_f32 v189, v189, v109
    v_add_f32 v190, v190, v110
    v_add_f32 v191, v191, v111
    v_cvt_pk_bf16_f32 v104, v104, v108
    v_cvt_pk_bf16_f32 v105, v105, v109
    v_cvt_pk_bf16_f32 v106, v106, v110
    v_cvt_pk_bf16_f32 v107, v107, v111
    ds_write_b128 v213, v[104:107] offset:24576
    v_cvt_pk_bf16_f32 v184, v184, v188
    v_cvt_pk_bf16_f32 v185, v185, v189
    v_cvt_pk_bf16_f32 v186, v186, v190
    v_cvt_pk_bf16_f32 v187, v187, v191
    ds_write_b128 v233, v[184:187] offset:4096
    v_mfma_f32_16x16x32_bf16 a[152:155], v[20:23], v[64:67], a[152:155]
    v_accvgpr_read_b32 v24, a229
    v_accvgpr_read_b32 v25, a230
    v_accvgpr_read_b32 v26, a231
    v_mfma_f32_16x16x32_bf16 a[156:159], v[64:67], v[64:67], a[156:159]
    v_accvgpr_read_b32 v27, a232
    v_accvgpr_read_b32 v28, a233
    v_accvgpr_read_b32 v29, a234
    v_mfma_f32_16x16x32_bf16 a[168:171], v[20:23], v[144:147], a[168:171]
    v_accvgpr_read_b32 v30, a235
    v_accvgpr_read_b32 v31, a236
    v_accvgpr_read_b32 v8, a237
    v_mfma_f32_16x16x32_bf16 a[172:175], v[144:147], v[144:147], a[172:175]
    v_accvgpr_read_b32 v9, a238
    v_accvgpr_read_b32 v10, a239
    v_accvgpr_read_b32 v11, a240
    v_mfma_f32_16x16x32_bf16 a[160:163], v[20:23], v[104:107], a[160:163]
    v_mfma_f32_16x16x32_bf16 a[164:167], v[104:107], v[104:107], a[164:167]
    v_mfma_f32_16x16x32_bf16 a[176:179], v[20:23], v[184:187], a[176:179]
    v_mfma_f32_16x16x32_bf16 a[180:183], v[184:187], v[184:187], a[180:183]
    s_add_u32 s52, s56, 0x14000
    v_add_u32 v4, s52, v3
    v_lshlrev_b32 v5, 2, v0
    v_add_u32 v5, s52, v5
    v_add_u32 v6, s52, v0
    s_mov_b32 exec_lo, 0x00010001
    s_mov_b32 exec_hi, 0x00010001
    ds_write_b128 v6, a[184:187] offset:5120
    ds_write_b128 v6, a[188:191] offset:5184
    ds_write_b128 v6, a[192:195] offset:5248
    s_mov_b64 exec, -1
    ds_write_b32 v5, a152 offset:4096
    ds_write_b128 v4, a[156:159] offset:0
    ds_write_b32 v5, a160 offset:4352
    ds_write_b128 v4, a[164:167] offset:1024
    ds_write_b32 v5, a168 offset:4608
    ds_write_b128 v4, a[172:175] offset:2048
    ds_write_b32 v5, a176 offset:4864
    ds_write_b128 v4, a[180:183] offset:3072
    s_waitcnt lgkmcnt(0)
    s_barrier
    ds_read_b128 a[120:123], v204 offset:0
    ds_read_b128 a[124:127], v205 offset:0
    ds_read_b128 a[128:131], v206 offset:0
    ds_read_b128 a[132:135], v207 offset:0
    ds_read_b128 a[136:139], v204 offset:1024
    ds_read_b128 a[140:143], v205 offset:1024
    ds_read_b128 a[144:147], v206 offset:1024
    ds_read_b128 a[148:151], v207 offset:1024
    s_waitcnt lgkmcnt(4)
    v_mfma_f32_16x16x32_bf16 v[32:35], a[0:3], a[120:123], 0
    ds_read_b128 a[152:155], v204 offset:2048
    v_mfma_f32_16x16x32_bf16 v[36:39], a[4:7], a[120:123], 0
    ds_read_b128 a[156:159], v205 offset:2048
    v_mfma_f32_16x16x32_bf16 v[40:43], a[8:11], a[120:123], 0
    ds_read_b128 a[160:163], v206 offset:2048
    v_mfma_f32_16x16x32_bf16 v[44:47], a[0:3], a[124:127], 0
    ds_read_b128 a[164:167], v207 offset:2048
    v_mfma_f32_16x16x32_bf16 v[48:51], a[4:7], a[124:127], 0
    ds_read_b128 a[168:171], v204 offset:3072
    v_mfma_f32_16x16x32_bf16 v[52:55], a[8:11], a[124:127], 0
    ds_read_b128 a[172:175], v205 offset:3072
    v_mfma_f32_16x16x32_bf16 v[56:59], a[0:3], a[128:131], 0
    s_waitcnt lgkmcnt(8)
    v_mfma_f32_16x16x32_bf16 v[60:63], a[4:7], a[128:131], 0
    ds_read_b128 a[176:179], v206 offset:3072
    v_mfma_f32_16x16x32_bf16 v[64:67], a[8:11], a[128:131], 0
    ds_read_b128 a[180:183], v207 offset:3072
    v_mfma_f32_16x16x32_bf16 v[68:71], a[0:3], a[132:135], 0
    ds_read_b128 a[184:187], v204 offset:4096
    v_mfma_f32_16x16x32_bf16 v[72:75], a[4:7], a[132:135], 0
    ds_read_b128 a[188:191], v205 offset:4096
    v_mfma_f32_16x16x32_bf16 v[76:79], a[8:11], a[132:135], 0
    ds_read_b128 a[192:195], v206 offset:4096
    ds_read_b128 a[196:199], v207 offset:4096
    ds_read_b128 a[200:203], v204 offset:5120
    s_waitcnt lgkmcnt(13)
    v_mfma_f32_16x16x32_bf16 v[32:35], a[12:15], a[136:139], v[32:35]
    ds_read_b128 a[204:207], v205 offset:5120
    v_mfma_f32_16x16x32_bf16 v[36:39], a[16:19], a[136:139], v[36:39]
    ds_read_b128 a[208:211], v206 offset:5120
    v_mfma_f32_16x16x32_bf16 v[40:43], a[20:23], a[136:139], v[40:43]
    ds_read_b128 a[212:215], v207 offset:5120
    v_mfma_f32_16x16x32_bf16 v[44:47], a[12:15], a[140:143], v[44:47]
    ds_read_b128 a[216:219], v204 offset:6144
    v_mfma_f32_16x16x32_bf16 v[48:51], a[16:19], a[140:143], v[48:51]
    ds_read_b128 a[220:223], v205 offset:6144
    v_mfma_f32_16x16x32_bf16 v[52:55], a[20:23], a[140:143], v[52:55]
    ds_read_b128 a[224:227], v206 offset:6144
    v_mfma_f32_16x16x32_bf16 v[56:59], a[12:15], a[144:147], v[56:59]
    s_waitcnt lgkmcnt(8)
    v_mfma_f32_16x16x32_bf16 v[60:63], a[16:19], a[144:147], v[60:63]
    ds_read_b128 a[228:231], v207 offset:6144
    v_mfma_f32_16x16x32_bf16 v[64:67], a[20:23], a[144:147], v[64:67]
    ds_read_b128 a[232:235], v204 offset:7168
    v_mfma_f32_16x16x32_bf16 v[68:71], a[12:15], a[148:151], v[68:71]
    ds_read_b128 a[236:239], v205 offset:7168
    v_mfma_f32_16x16x32_bf16 v[72:75], a[16:19], a[148:151], v[72:75]
    ds_read_b128 a[240:243], v206 offset:7168
    v_mfma_f32_16x16x32_bf16 v[76:79], a[20:23], a[148:151], v[76:79]
    ds_read_b128 a[244:247], v207 offset:7168
    ds_read_b128 a[248:251], v204 offset:8192
    ds_read_b128 a[252:255], v205 offset:8192
    s_waitcnt lgkmcnt(15)
    v_mfma_f32_16x16x32_bf16 v[32:35], a[24:27], a[152:155], v[32:35]
    ds_read_b128 v[212:215], v206 offset:8192
    v_mfma_f32_16x16x32_bf16 v[36:39], a[28:31], a[152:155], v[36:39]
    ds_read_b128 v[216:219], v207 offset:8192
    v_mfma_f32_16x16x32_bf16 v[40:43], a[32:35], a[152:155], v[40:43]
    ds_read_b128 v[220:223], v204 offset:9216
    v_mfma_f32_16x16x32_bf16 v[44:47], a[24:27], a[156:159], v[44:47]
    ds_read_b128 v[224:227], v205 offset:9216
    v_mfma_f32_16x16x32_bf16 v[48:51], a[28:31], a[156:159], v[48:51]
    ds_read_b128 v[228:231], v206 offset:9216
    v_mfma_f32_16x16x32_bf16 v[52:55], a[32:35], a[156:159], v[52:55]
    ds_read_b128 v[232:235], v207 offset:9216
    v_mfma_f32_16x16x32_bf16 v[56:59], a[24:27], a[160:163], v[56:59]
    s_waitcnt lgkmcnt(8)
    v_mfma_f32_16x16x32_bf16 v[60:63], a[28:31], a[160:163], v[60:63]
    ds_read_b32 v144, v210 offset:4096
    v_mfma_f32_16x16x32_bf16 v[64:67], a[32:35], a[160:163], v[64:67]
    ds_read_b32 v145, v210 offset:24576
    v_mfma_f32_16x16x32_bf16 v[68:71], a[24:27], a[164:167], v[68:71]
    ds_read_b32 v146, v211 offset:4608
    v_mfma_f32_16x16x32_bf16 v[72:75], a[28:31], a[164:167], v[72:75]
    ds_read_b32 v147, v211 offset:25088
    v_mfma_f32_16x16x32_bf16 v[76:79], a[32:35], a[164:167], v[76:79]
    ds_read_b32 v148, v208 offset:0
    ds_read_b32 v149, v208 offset:20480
    ds_read_b32 v150, v209 offset:2048
    s_waitcnt lgkmcnt(15)
    v_mfma_f32_16x16x32_bf16 v[32:35], a[36:39], a[168:171], v[32:35]
    ds_read_b32 v151, v209 offset:22528
    v_mfma_f32_16x16x32_bf16 v[36:39], a[40:43], a[168:171], v[36:39]
    ds_read_b128 v[128:131], v254
    v_mfma_f32_16x16x32_bf16 v[40:43], a[44:47], a[168:171], v[40:43]
    ds_read_b128 v[132:135], v251
    v_mfma_f32_16x16x32_bf16 v[44:47], a[36:39], a[172:175], v[44:47]
    ds_read_b64 v[136:137], v252
    v_mfma_f32_16x16x32_bf16 v[48:51], a[40:43], a[172:175], v[48:51]
    ds_read_u16 v138, v253
    v_mfma_f32_16x16x32_bf16 v[52:55], a[44:47], a[172:175], v[52:55]
    ds_read_u16 v139, v236
    v_mfma_f32_16x16x32_bf16 v[56:59], a[36:39], a[176:179], v[56:59]
    s_waitcnt lgkmcnt(8)
    v_mfma_f32_16x16x32_bf16 v[60:63], a[40:43], a[176:179], v[60:63]
    ds_read_u16 v140, v237
    v_mfma_f32_16x16x32_bf16 v[64:67], a[44:47], a[176:179], v[64:67]
    v_lshlrev_b32 v4, 4, v2
    v_mfma_f32_16x16x32_bf16 v[68:71], a[36:39], a[180:183], v[68:71]
    v_add_u32 v6, 0x1e000, v4
    v_mfma_f32_16x16x32_bf16 v[72:75], a[40:43], a[180:183], v[72:75]
    v_add_u32 v4, 0x14000, v4
    v_mfma_f32_16x16x32_bf16 v[76:79], a[44:47], a[180:183], v[76:79]
    ds_read_b128 v[80:83], v4 offset:5120
    ds_read_b128 v[84:87], v4 offset:5184
    ds_read_b128 v[88:91], v4 offset:5248
    s_waitcnt lgkmcnt(15)
    v_mfma_f32_16x16x32_bf16 v[32:35], a[48:51], a[184:187], v[32:35]
    ds_read_b128 v[104:107], v4 offset:25600
    v_mfma_f32_16x16x32_bf16 v[36:39], a[52:55], a[184:187], v[36:39]
    ds_read_b128 v[108:111], v4 offset:25664
    v_mfma_f32_16x16x32_bf16 v[40:43], a[56:59], a[184:187], v[40:43]
    ds_read_b128 v[112:115], v4 offset:25728
    v_mfma_f32_16x16x32_bf16 v[44:47], a[48:51], a[188:191], v[44:47]
    ds_read_b128 v[92:95], v6 offset:5120
    v_mfma_f32_16x16x32_bf16 v[48:51], a[52:55], a[188:191], v[48:51]
    ds_read_b128 v[96:99], v6 offset:5184
    v_mfma_f32_16x16x32_bf16 v[52:55], a[56:59], a[188:191], v[52:55]
    ds_read_b128 v[100:103], v6 offset:5248
    v_mfma_f32_16x16x32_bf16 v[56:59], a[48:51], a[192:195], v[56:59]
    s_waitcnt lgkmcnt(8)
    v_mfma_f32_16x16x32_bf16 v[60:63], a[52:55], a[192:195], v[60:63]
    ds_read_b128 v[116:119], v6 offset:25600
    v_mfma_f32_16x16x32_bf16 v[64:67], a[56:59], a[192:195], v[64:67]
    ds_read_b128 v[120:123], v6 offset:25664
    v_mfma_f32_16x16x32_bf16 v[68:71], a[48:51], a[196:199], v[68:71]
    ds_read_b128 v[124:127], v6 offset:25728
    v_mfma_f32_16x16x32_bf16 v[72:75], a[52:55], a[196:199], v[72:75]
    v_mfma_f32_16x16x32_bf16 v[76:79], a[56:59], a[196:199], v[76:79]
    v_mfma_f32_16x16x32_bf16 v[32:35], a[60:63], a[200:203], v[32:35]
    v_mfma_f32_16x16x32_bf16 v[36:39], a[64:67], a[200:203], v[36:39]
    v_mfma_f32_16x16x32_bf16 v[40:43], a[68:71], a[200:203], v[40:43]
    v_mfma_f32_16x16x32_bf16 v[44:47], a[60:63], a[204:207], v[44:47]
    s_waitcnt lgkmcnt(0)
    s_add_u32 m0, s62, 0
    s_barrier
    v_mfma_f32_16x16x32_bf16 v[48:51], a[64:67], a[204:207], v[48:51]
    v_add_f32 v144, v144, v145
    v_add_f32 v146, v146, v147
    s_sub_u32 s64, s90, 1536
    s_mul_i32 s63, s92, 0
    s_add_u32 s63, s63, s91
    s_add_u32 s63, s63, s64
    buffer_load_dwordx4 v241, s[16:19], s64 offen lds
    v_mfma_f32_16x16x32_bf16 v[52:55], a[68:71], a[204:207], v[52:55]
    s_add_u32 m0, s62, 1024
    v_add_f32 v148, v148, v149
    v_add_f32 v150, v150, v151
    v_mfma_f32_16x16x32_bf16 v[56:59], a[60:63], a[208:211], v[56:59]
    v_add_f32 v144, v144, v146
    v_add_f32 v148, v148, v150
    v_mfma_f32_16x16x32_bf16 v[60:63], a[64:67], a[208:211], v[60:63]
    v_mul_f32 v192, 0xbacccccd, v144
    v_mov_b32 v4, 0x3727c5ac
    buffer_load_dwordx4 v239, s[16:19], s63 offen lds
    v_mfma_f32_16x16x32_bf16 v[64:67], a[68:71], a[208:211], v[64:67]
    s_add_u32 m0, s62, 2048
    v_fmac_f32 v4, 0x3acccccd, v148
    v_fma_f32 v4, -v192, v192, v4
    v_mfma_f32_16x16x32_bf16 v[68:71], a[60:63], a[212:215], v[68:71]
    v_rsq_f32 v193, v4
    v_mul_f32 v196, 0x3727c5ac, v4
    v_mfma_f32_16x16x32_bf16 v[72:75], a[64:67], a[212:215], v[72:75]
    v_mul_f32 v194, 0xc0135761, v193
    v_mul_f32 v4, v193, v193
    buffer_load_dwordx4 v240, s[16:19], s63 offen lds
    v_mfma_f32_16x16x32_bf16 v[76:79], a[68:71], a[212:215], v[76:79]
    s_add_u32 m0, s62, 6144
    s_add_u32 s63, s63, s92
    v_mul_f32 v4, 0x3d372713, v4
    v_mul_f32 v195, v4, v194
    v_mfma_f32_16x16x32_bf16 v[32:35], a[72:75], a[216:219], v[32:35]
    v_add_f32 v80, v80, v104
    v_add_f32 v81, v81, v105
    v_mfma_f32_16x16x32_bf16 v[36:39], a[76:79], a[216:219], v[36:39]
    v_add_f32 v82, v82, v106
    v_add_f32 v83, v83, v107
    buffer_load_dwordx4 v238, s[16:19], s63 offen lds
    v_mfma_f32_16x16x32_bf16 v[40:43], a[80:83], a[216:219], v[40:43]
    s_add_u32 m0, s62, 7168
    v_add_f32 v84, v84, v108
    v_add_f32 v85, v85, v109
    v_mfma_f32_16x16x32_bf16 v[44:47], a[72:75], a[220:223], v[44:47]
    v_add_f32 v86, v86, v110
    v_add_f32 v87, v87, v111
    v_mfma_f32_16x16x32_bf16 v[48:51], a[76:79], a[220:223], v[48:51]
    v_add_f32 v88, v88, v112
    v_add_f32 v89, v89, v113
    buffer_load_dwordx4 v239, s[16:19], s63 offen lds
    v_mfma_f32_16x16x32_bf16 v[52:55], a[80:83], a[220:223], v[52:55]
    s_add_u32 m0, s62, 8192
    v_add_f32 v90, v90, v114
    v_add_f32 v91, v91, v115
    v_mfma_f32_16x16x32_bf16 v[56:59], a[72:75], a[224:227], v[56:59]
    v_add_f32 v92, v92, v116
    v_add_f32 v93, v93, v117
    v_mfma_f32_16x16x32_bf16 v[60:63], a[76:79], a[224:227], v[60:63]
    v_add_f32 v94, v94, v118
    v_add_f32 v95, v95, v119
    buffer_load_dwordx4 v240, s[16:19], s63 offen lds
    v_mfma_f32_16x16x32_bf16 v[64:67], a[80:83], a[224:227], v[64:67]
    s_add_u32 m0, s62, 12288
    s_add_u32 s63, s63, s92
    v_add_f32 v96, v96, v120
    v_add_f32 v97, v97, v121
    v_mfma_f32_16x16x32_bf16 v[68:71], a[72:75], a[228:231], v[68:71]
    v_add_f32 v98, v98, v122
    v_add_f32 v99, v99, v123
    v_mfma_f32_16x16x32_bf16 v[72:75], a[76:79], a[228:231], v[72:75]
    v_add_f32 v100, v100, v124
    v_add_f32 v101, v101, v125
    buffer_load_dwordx4 v238, s[16:19], s63 offen lds
    s_add_u32 m0, s62, 13312
    v_mfma_f32_16x16x32_bf16 v[76:79], a[80:83], a[228:231], v[76:79]
    v_add_f32 v102, v102, v126
    v_add_f32 v103, v103, v127
    v_mfma_f32_16x16x32_bf16 v[44:47], a[84:87], a[236:239], v[44:47]
    v_mfma_f32_16x16x32_bf16 v[48:51], a[88:91], a[236:239], v[48:51]
    v_mfma_f32_16x16x32_bf16 v[52:55], a[92:95], a[236:239], v[52:55]
    buffer_load_dwordx4 v239, s[16:19], s63 offen lds
    s_add_u32 m0, s62, 14336
    v_mfma_f32_16x16x32_bf16 v[44:47], a[96:99], a[252:255], v[44:47]
    v_mfma_f32_16x16x32_bf16 v[48:51], a[100:103], a[252:255], v[48:51]
    v_mfma_f32_16x16x32_bf16 v[52:55], a[104:107], a[252:255], v[52:55]
    buffer_load_dwordx4 v240, s[16:19], s63 offen lds
    s_add_u32 m0, s62, 18432
    s_add_u32 s63, s63, s92
    v_mfma_f32_16x16x32_bf16 v[44:47], a[108:111], v[224:227], v[44:47]
    v_mfma_f32_16x16x32_bf16 v[48:51], a[112:115], v[224:227], v[48:51]
    v_mfma_f32_16x16x32_bf16 v[52:55], a[116:119], v[224:227], v[52:55]
    buffer_load_dwordx4 v238, s[16:19], s63 offen lds
    s_add_u32 m0, s62, 19456
    v_mfma_f32_16x16x32_bf16 v[56:59], a[84:87], a[240:243], v[56:59]
    v_mfma_f32_16x16x32_bf16 v[60:63], a[88:91], a[240:243], v[60:63]
    v_mfma_f32_16x16x32_bf16 v[64:67], a[92:95], a[240:243], v[64:67]
    buffer_load_dwordx4 v239, s[16:19], s63 offen lds
    s_add_u32 m0, s62, 20480
    v_mfma_f32_16x16x32_bf16 v[56:59], a[96:99], v[212:215], v[56:59]
    v_mfma_f32_16x16x32_bf16 v[60:63], a[100:103], v[212:215], v[60:63]
    ds_write_b128 v201, v[44:47] offset:0
    v_mfma_f32_16x16x32_bf16 v[64:67], a[104:107], v[212:215], v[64:67]
    buffer_load_dwordx4 v240, s[16:19], s63 offen lds
    s_add_u32 m0, s62, 24576
    s_add_u32 s63, s63, s92
    v_mfma_f32_16x16x32_bf16 v[56:59], a[108:111], v[228:231], v[56:59]
    ds_write_b128 v201, v[48:51] offset:1024
    v_mfma_f32_16x16x32_bf16 v[60:63], a[112:115], v[228:231], v[60:63]
    v_mfma_f32_16x16x32_bf16 v[64:67], a[116:119], v[228:231], v[64:67]
    ds_write_b128 v201, v[52:55] offset:2048
    buffer_load_dwordx4 v238, s[16:19], s63 offen lds
    s_add_u32 m0, s62, 25600
    v_mfma_f32_16x16x32_bf16 v[68:71], a[84:87], a[244:247], v[68:71]
    v_mfma_f32_16x16x32_bf16 v[72:75], a[88:91], a[244:247], v[72:75]
    v_mfma_f32_16x16x32_bf16 v[76:79], a[92:95], a[244:247], v[76:79]
    buffer_load_dwordx4 v239, s[16:19], s63 offen lds
    s_add_u32 m0, s62, 26624
    v_mfma_f32_16x16x32_bf16 v[68:71], a[96:99], v[216:219], v[68:71]
    v_mfma_f32_16x16x32_bf16 v[72:75], a[100:103], v[216:219], v[72:75]
    ds_write_b128 v202, v[56:59] offset:0
    v_mfma_f32_16x16x32_bf16 v[76:79], a[104:107], v[216:219], v[76:79]
    buffer_load_dwordx4 v240, s[16:19], s63 offen lds
    v_mfma_f32_16x16x32_bf16 v[68:71], a[108:111], v[232:235], v[68:71]
    ds_write_b128 v202, v[60:63] offset:1024
    v_mfma_f32_16x16x32_bf16 v[72:75], a[112:115], v[232:235], v[72:75]
    v_mfma_f32_16x16x32_bf16 v[76:79], a[116:119], v[232:235], v[76:79]
    ds_write_b128 v202, v[64:67] offset:2048
    s_sub_u32 s64, s90, 1536
    s_mul_i32 s63, s92, 5
    s_add_u32 s63, s63, s91
    s_add_u32 s63, s63, s64
    s_add_u32 m0, s62, 81920
    s_nop 0
    buffer_load_dwordx4 v238, s[16:19], s63 offen lds
    s_add_u32 m0, s62, 82944
    v_mfma_f32_16x16x32_bf16 v[32:35], a[84:87], a[232:235], v[32:35]
    v_mfma_f32_16x16x32_bf16 v[36:39], a[88:91], a[232:235], v[36:39]
    v_mfma_f32_16x16x32_bf16 v[40:43], a[92:95], a[232:235], v[40:43]
    buffer_load_dwordx4 v239, s[16:19], s63 offen lds
    s_add_u32 m0, s62, 83968
    v_mfma_f32_16x16x32_bf16 v[32:35], a[96:99], a[248:251], v[32:35]
    v_mfma_f32_16x16x32_bf16 v[36:39], a[100:103], a[248:251], v[36:39]
    ds_write_b128 v203, v[68:71] offset:0
    v_mfma_f32_16x16x32_bf16 v[40:43], a[104:107], a[248:251], v[40:43]
    buffer_load_dwordx4 v240, s[16:19], s63 offen lds
    s_add_u32 m0, s62, 88064
    s_add_u32 s63, s63, s92
    v_mfma_f32_16x16x32_bf16 v[32:35], a[108:111], v[220:223], v[32:35]
    ds_write_b128 v203, v[72:75] offset:1024
    v_mfma_f32_16x16x32_bf16 v[36:39], a[112:115], v[220:223], v[36:39]
    v_mfma_f32_16x16x32_bf16 v[40:43], a[116:119], v[220:223], v[40:43]
    ds_write_b128 v203, v[76:79] offset:2048
    buffer_load_dwordx4 v238, s[16:19], s63 offen lds
    s_waitcnt lgkmcnt(0)
    s_barrier
    ds_read_b128 v[152:155], v200 offset:0
    s_add_u32 m0, s62, 89088
    ds_read_b128 v[156:159], v200 offset:1024
    ds_read_b128 v[160:163], v200 offset:2048
    ds_read_b128 v[164:167], v200 offset:3072
    ds_read_b128 v[168:171], v200 offset:4096
    ds_read_b128 v[172:175], v200 offset:5120
    ds_read_b128 v[176:179], v200 offset:6144
    ds_read_b128 v[180:183], v200 offset:7168
    ds_read_b128 v[184:187], v200 offset:8192
    buffer_load_dwordx4 v239, s[16:19], s63 offen lds
    s_lshl_b32 s93, s47, 2
    s_add_u32 s93, s93, s44
    s_lshl_b32 s93, s93, 11
    s_add_u32 s93, s93, 0xc00000
    s_lshl_b32 s96, s48, 8
    s_add_u32 s96, s96, s93
    s_cmp_eq_u32 s51, 0
    s_cbranch_scc0 L_x2_b
    s_waitcnt lgkmcnt(0)
    v_pk_add_f32 v[44:45], v[32:33], v[152:153]
    v_pk_add_f32 v[46:47], v[34:35], v[154:155]
    v_pk_add_f32 v[48:49], v[36:37], v[156:157]
    v_pk_add_f32 v[50:51], v[38:39], v[158:159]
    v_pk_add_f32 v[52:53], v[40:41], v[160:161]
    v_pk_add_f32 v[54:55], v[42:43], v[162:163]
    v_pk_add_f32 v[56:57], v[164:165], v[176:177]
    v_pk_add_f32 v[58:59], v[166:167], v[178:179]
    v_pk_add_f32 v[60:61], v[168:169], v[180:181]
    v_pk_add_f32 v[62:63], v[170:171], v[182:183]
    v_pk_add_f32 v[64:65], v[172:173], v[184:185]
    v_pk_add_f32 v[66:67], v[174:175], v[186:187]
    s_branch L_x2_d
L_x2_b:
    s_waitcnt lgkmcnt(0)
    v_pk_add_f32 v[56:57], v[32:33], v[152:153]
    v_pk_add_f32 v[58:59], v[34:35], v[154:155]
    v_pk_add_f32 v[60:61], v[36:37], v[156:157]
    v_pk_add_f32 v[62:63], v[38:39], v[158:159]
    v_pk_add_f32 v[64:65], v[40:41], v[160:161]
    v_pk_add_f32 v[66:67], v[42:43], v[162:163]
    v_pk_add_f32 v[44:45], v[164:165], v[176:177]
    v_pk_add_f32 v[46:47], v[166:167], v[178:179]
    v_pk_add_f32 v[48:49], v[168:169], v[180:181]
    v_pk_add_f32 v[50:51], v[170:171], v[182:183]
    v_pk_add_f32 v[52:53], v[172:173], v[184:185]
    v_pk_add_f32 v[54:55], v[174:175], v[186:187]
L_x2_d:
    s_add_u32 m0, s62, 90112
    s_nop 0
    buffer_load_dwordx4 v240, s[16:19], s63 offen lds
    v_pk_fma_f32 v[44:45], v[80:81], v[192:193], v[44:45] op_sel_hi:[1,0,1]
    s_add_u32 m0, s62, 94208
    s_add_u32 s63, s63, s92
    v_pk_fma_f32 v[46:47], v[82:83], v[192:193], v[46:47] op_sel_hi:[1,0,1]
    v_pk_fma_f32 v[48:49], v[84:85], v[192:193], v[48:49] op_sel_hi:[1,0,1]
    v_pk_fma_f32 v[50:51], v[86:87], v[192:193], v[50:51] op_sel_hi:[1,0,1]
    v_pk_fma_f32 v[52:53], v[88:89], v[192:193], v[52:53] op_sel_hi:[1,0,1]
    v_pk_fma_f32 v[54:55], v[90:91], v[192:193], v[54:55] op_sel_hi:[1,0,1]
    v_pk_fma_f32 v[56:57], v[92:93], v[192:193], v[56:57] op_sel_hi:[1,0,1]
    v_pk_fma_f32 v[58:59], v[94:95], v[192:193], v[58:59] op_sel_hi:[1,0,1]
    v_pk_fma_f32 v[60:61], v[96:97], v[192:193], v[60:61] op_sel_hi:[1,0,1]
    buffer_load_dwordx4 v238, s[16:19], s63 offen lds
    v_pk_fma_f32 v[62:63], v[98:99], v[192:193], v[62:63] op_sel_hi:[1,0,1]
    s_add_u32 m0, s62, 95232
    v_pk_fma_f32 v[64:65], v[100:101], v[192:193], v[64:65] op_sel_hi:[1,0,1]
    v_pk_fma_f32 v[66:67], v[102:103], v[192:193], v[66:67] op_sel_hi:[1,0,1]
    v_pk_mul_f32 v[104:105], v[44:45], v[44:45]
    v_pk_mul_f32 v[106:107], v[46:47], v[46:47]
    v_pk_mul_f32 v[108:109], v[48:49], v[48:49]
    v_pk_mul_f32 v[110:111], v[50:51], v[50:51]
    v_pk_mul_f32 v[112:113], v[52:53], v[52:53]
    v_pk_mul_f32 v[114:115], v[54:55], v[54:55]
    buffer_load_dwordx4 v239, s[16:19], s63 offen lds
    v_pk_mul_f32 v[116:117], v[56:57], v[56:57]
    s_add_u32 m0, s62, 96256
    v_pk_mul_f32 v[118:119], v[58:59], v[58:59]
    v_pk_mul_f32 v[120:121], v[60:61], v[60:61]
    v_pk_mul_f32 v[122:123], v[62:63], v[62:63]
    v_pk_mul_f32 v[124:125], v[64:65], v[64:65]
    v_pk_mul_f32 v[126:127], v[66:67], v[66:67]
    v_pk_fma_f32 v[104:105], v[104:105], v[194:195], v[194:195] op_sel:[0,1,0] op_sel_hi:[1,1,0]
    v_pk_fma_f32 v[106:107], v[106:107], v[194:195], v[194:195] op_sel:[0,1,0] op_sel_hi:[1,1,0]
    v_pk_fma_f32 v[108:109], v[108:109], v[194:195], v[194:195] op_sel:[0,1,0] op_sel_hi:[1,1,0]
    buffer_load_dwordx4 v240, s[16:19], s63 offen lds
    v_pk_fma_f32 v[110:111], v[110:111], v[194:195], v[194:195] op_sel:[0,1,0] op_sel_hi:[1,1,0]
    s_add_u32 m0, s62, 100352
    s_add_u32 s63, s63, s92
    v_pk_fma_f32 v[112:113], v[112:113], v[194:195], v[194:195] op_sel:[0,1,0] op_sel_hi:[1,1,0]
    v_pk_fma_f32 v[114:115], v[114:115], v[194:195], v[194:195] op_sel:[0,1,0] op_sel_hi:[1,1,0]
    v_pk_fma_f32 v[116:117], v[116:117], v[194:195], v[194:195] op_sel:[0,1,0] op_sel_hi:[1,1,0]
    v_pk_fma_f32 v[118:119], v[118:119], v[194:195], v[194:195] op_sel:[0,1,0] op_sel_hi:[1,1,0]
    v_pk_fma_f32 v[120:121], v[120:121], v[194:195], v[194:195] op_sel:[0,1,0] op_sel_hi:[1,1,0]
    v_pk_fma_f32 v[122:123], v[122:123], v[194:195], v[194:195] op_sel:[0,1,0] op_sel_hi:[1,1,0]
    v_pk_fma_f32 v[124:125], v[124:125], v[194:195], v[194:195] op_sel:[0,1,0] op_sel_hi:[1,1,0]
    v_pk_fma_f32 v[126:127], v[126:127], v[194:195], v[194:195] op_sel:[0,1,0] op_sel_hi:[1,1,0]
    buffer_load_dwordx4 v238, s[16:19], s63 offen lds
    v_pk_mul_f32 v[104:105], v[104:105], v[44:45]
    s_add_u32 m0, s62, 101376
    v_pk_mul_f32 v[106:107], v[106:107], v[46:47]
    v_pk_mul_f32 v[108:109], v[108:109], v[48:49]
    v_pk_mul_f32 v[110:111], v[110:111], v[50:51]
    v_pk_mul_f32 v[112:113], v[112:113], v[52:53]
    v_pk_mul_f32 v[114:115], v[114:115], v[54:55]
    v_pk_mul_f32 v[116:117], v[116:117], v[56:57]
    v_pk_mul_f32 v[118:119], v[118:119], v[58:59]
    v_pk_mul_f32 v[120:121], v[120:121], v[60:61]
    buffer_load_dwordx4 v239, s[16:19], s63 offen lds
    v_pk_mul_f32 v[122:123], v[122:123], v[62:63]
    s_add_u32 m0, s62, 102400
    v_pk_mul_f32 v[124:125], v[124:125], v[64:65]
    v_pk_mul_f32 v[126:127], v[126:127], v[66:67]
    v_exp_f32 v104, v104
    v_exp_f32 v105, v105
    v_exp_f32 v106, v106
    v_exp_f32 v107, v107
    v_exp_f32 v108, v108
    v_exp_f32 v109, v109
    buffer_load_dwordx4 v240, s[16:19], s63 offen lds
    v_exp_f32 v110, v110
    s_add_u32 m0, s62, 106496
    s_add_u32 s63, s63, s92
    v_exp_f32 v111, v111
    v_exp_f32 v112, v112
    v_exp_f32 v113, v113
    v_exp_f32 v114, v114
    v_exp_f32 v115, v115
    v_exp_f32 v116, v116
    v_exp_f32 v117, v117
    v_exp_f32 v118, v118
    buffer_load_dwordx4 v238, s[16:19], s63 offen lds
    v_exp_f32 v119, v119
    s_add_u32 m0, s62, 107520
    v_exp_f32 v120, v120
    v_exp_f32 v121, v121
    v_exp_f32 v122, v122
    v_exp_f32 v123, v123
    v_exp_f32 v124, v124
    v_exp_f32 v125, v125
    v_exp_f32 v126, v126
    v_exp_f32 v127, v127
    buffer_load_dwordx4 v239, s[16:19], s63 offen lds
    v_pk_add_f32 v[104:105], v[104:105], 1.0 op_sel_hi:[1,0]
    s_add_u32 m0, s62, 108544
    v_pk_add_f32 v[106:107], v[106:107], 1.0 op_sel_hi:[1,0]
    v_pk_add_f32 v[108:109], v[108:109], 1.0 op_sel_hi:[1,0]
    v_pk_add_f32 v[110:111], v[110:111], 1.0 op_sel_hi:[1,0]
    v_pk_add_f32 v[112:113], v[112:113], 1.0 op_sel_hi:[1,0]
    v_pk_add_f32 v[114:115], v[114:115], 1.0 op_sel_hi:[1,0]
    v_pk_add_f32 v[116:117], v[116:117], 1.0 op_sel_hi:[1,0]
    v_pk_add_f32 v[118:119], v[118:119], 1.0 op_sel_hi:[1,0]
    v_pk_add_f32 v[120:121], v[120:121], 1.0 op_sel_hi:[1,0]
    buffer_load_dwordx4 v240, s[16:19], s63 offen lds
    v_pk_add_f32 v[122:123], v[122:123], 1.0 op_sel_hi:[1,0]
    s_add_u32 m0, s76, 0
    s_add_u32 s65, s68, 0
    v_pk_add_f32 v[124:125], v[124:125], 1.0 op_sel_hi:[1,0]
    v_pk_add_f32 v[126:127], v[126:127], 1.0 op_sel_hi:[1,0]
    v_rcp_f32 v104, v104
    v_rcp_f32 v105, v105
    v_rcp_f32 v106, v106
    v_rcp_f32 v107, v107
    v_rcp_f32 v108, v108
    v_rcp_f32 v109, v109
    buffer_load_dwordx4 v24, s[20:23], s65 offen lds
    v_rcp_f32 v110, v110
    s_add_u32 m0, s76, 1024
    s_add_u32 s65, s68, 0
    v_rcp_f32 v111, v111
    v_rcp_f32 v112, v112
    v_rcp_f32 v113, v113
    v_rcp_f32 v114, v114
    v_rcp_f32 v115, v115
    v_rcp_f32 v116, v116
    v_rcp_f32 v117, v117
    v_rcp_f32 v118, v118
    buffer_load_dwordx4 v25, s[20:23], s65 offen lds
    v_rcp_f32 v119, v119
    s_add_u32 m0, s76, 2048
    s_add_u32 s65, s68, 0
    v_rcp_f32 v120, v120
    v_rcp_f32 v121, v121
    v_rcp_f32 v122, v122
    v_rcp_f32 v123, v123
    v_rcp_f32 v124, v124
    v_rcp_f32 v125, v125
    v_rcp_f32 v126, v126
    v_rcp_f32 v127, v127
    buffer_load_dwordx4 v26, s[20:23], s65 offen lds
    v_pk_mul_f32 v[44:45], v[44:45], v[104:105]
    s_add_u32 m0, s76, 3072
    s_add_u32 s65, s68, 0
    v_pk_mul_f32 v[46:47], v[46:47], v[106:107]
    v_pk_mul_f32 v[48:49], v[48:49], v[108:109]
    v_pk_mul_f32 v[50:51], v[50:51], v[110:111]
    v_pk_mul_f32 v[52:53], v[52:53], v[112:113]
    v_pk_mul_f32 v[54:55], v[54:55], v[114:115]
    v_pk_mul_f32 v[56:57], v[56:57], v[116:117]
    v_pk_mul_f32 v[58:59], v[58:59], v[118:119]
    v_pk_mul_f32 v[60:61], v[60:61], v[120:121]
    buffer_load_dwordx4 v27, s[20:23], s65 offen lds
    v_pk_mul_f32 v[62:63], v[62:63], v[122:123]
    s_add_u32 m0, s76, 4096
    s_add_u32 s65, s68, 0
    v_pk_mul_f32 v[64:65], v[64:65], v[124:125]
    v_pk_mul_f32 v[66:67], v[66:67], v[126:127]
    v_pk_add_f32 v[104:105], v[44:45], v[46:47]
    v_pk_mul_f32 v[106:107], v[44:45], v[44:45]
    v_pk_fma_f32 v[106:107], v[46:47], v[46:47], v[106:107]
    v_pk_add_f32 v[104:105], v[104:105], v[48:49]
    v_pk_fma_f32 v[106:107], v[48:49], v[48:49], v[106:107]
    v_pk_add_f32 v[104:105], v[104:105], v[50:51]
    buffer_load_dwordx4 v28, s[20:23], s65 offen lds
    v_pk_fma_f32 v[106:107], v[50:51], v[50:51], v[106:107]
    s_add_u32 m0, s76, 5120
    s_add_u32 s65, s68, 0
    v_pk_add_f32 v[104:105], v[104:105], v[52:53]
    v_pk_fma_f32 v[106:107], v[52:53], v[52:53], v[106:107]
    v_pk_add_f32 v[104:105], v[104:105], v[54:55]
    v_pk_fma_f32 v[106:107], v[54:55], v[54:55], v[106:107]
    v_pk_add_f32 v[104:105], v[104:105], v[56:57]
    v_pk_fma_f32 v[106:107], v[56:57], v[56:57], v[106:107]
    v_pk_add_f32 v[104:105], v[104:105], v[58:59]
    v_pk_fma_f32 v[106:107], v[58:59], v[58:59], v[106:107]
    buffer_load_dwordx4 v29, s[20:23], s65 offen lds
    v_pk_add_f32 v[104:105], v[104:105], v[60:61]
    v_pk_fma_f32 v[106:107], v[60:61], v[60:61], v[106:107]
    v_pk_add_f32 v[104:105], v[104:105], v[62:63]
    v_pk_fma_f32 v[106:107], v[62:63], v[62:63], v[106:107]
    s_add_u32 m0, s76, 6144
    s_add_u32 s65, s68, 0
    v_pk_add_f32 v[104:105], v[104:105], v[64:65]
    v_pk_fma_f32 v[106:107], v[64:65], v[64:65], v[106:107]
    v_pk_add_f32 v[104:105], v[104:105], v[66:67]
    v_pk_fma_f32 v[106:107], v[66:67], v[66:67], v[106:107]
    v_add_f32 v104, v104, v105
    s_waitcnt vmcnt(4)
    ds_read_b128 a[48:51], v10 offset:0
    ds_read_b128 a[52:55], v11 offset:0
    buffer_load_dwordx4 v30, s[20:23], s65 offen lds
    s_add_u32 m0, s76, 7168
    s_add_u32 s65, s68, 0
    v_add_f32 v105, v106, v107
    v_mov_b32 v106, s49
    v_mov_b32 v107, s49
    buffer_load_dwordx4 v31, s[20:23], s65 offen lds
    s_nop 1
    v_permlane32_swap_b32 v104, v105
    v_add_f32 v104, v104, v105
    v_mov_b32 v105, v104
    s_nop 1
    v_permlane16_swap_b32 v104, v105
    v_add_f32 v104, v104, v105
    v_mov_b32 v105, v104
    s_nop 1
    v_permlane32_swap_b32 v104, v105
    s_mov_b64 exec, 0xffff
    buffer_store_dwordx4 v[104:107], v3, s[32:35], s96 offen sc1
    s_mov_b64 exec, -1
    s_waitcnt vmcnt(24)
    s_barrier
    ds_read_b64_tr_b16 v[80:81], v14 offset:0
    ds_read_b64_tr_b16 v[82:83], v14 offset:768
    ds_read_b64_tr_b16 v[84:85], v15 offset:32
    ds_read_b64_tr_b16 v[86:87], v15 offset:800
    ds_read_b64_tr_b16 v[88:89], v14 offset:64
    ds_read_b64_tr_b16 v[90:91], v14 offset:832
    s_waitcnt lgkmcnt(0)
    s_add_u32 m0, s76, 0
    s_add_u32 s65, s68, 128
    v_mfma_f32_16x16x32_bf16 a[0:3], v[80:83], a[120:123], 0
    v_mfma_f32_16x16x32_bf16 a[4:7], v[84:87], a[120:123], 0
    ds_read_b64_tr_b16 v[92:93], v14 offset:6144
    v_mfma_f32_16x16x32_bf16 a[8:11], v[88:91], a[120:123], 0
    s_waitcnt vmcnt(5)
    ds_read_b128 a[56:59], v10 offset:2048
    ds_read_b128 a[60:63], v11 offset:2048
    s_waitcnt lgkmcnt(9)
    buffer_load_dwordx4 v24, s[20:23], s65 offen lds
    s_add_u32 m0, s76, 1024
    s_add_u32 s65, s68, 128
    v_mfma_f32_16x16x32_bf16 a[12:15], v[80:83], a[124:127], 0
    ds_read_b64_tr_b16 v[94:95], v14 offset:6912
    v_mfma_f32_16x16x32_bf16 a[16:19], v[84:87], a[124:127], 0
    v_mfma_f32_16x16x32_bf16 a[20:23], v[88:91], a[124:127], 0
    ds_read_b64_tr_b16 v[96:97], v15 offset:6176
    v_mfma_f32_16x16x32_bf16 a[24:27], v[80:83], a[128:131], 0
    buffer_load_dwordx4 v25, s[20:23], s65 offen lds
    v_mfma_f32_16x16x32_bf16 a[28:31], v[84:87], a[128:131], 0
    ds_read_b64_tr_b16 v[98:99], v15 offset:6944
    s_add_u32 m0, s76, 2048
    s_add_u32 s65, s68, 128
    v_mfma_f32_16x16x32_bf16 a[32:35], v[88:91], a[128:131], 0
    v_mfma_f32_16x16x32_bf16 a[36:39], v[80:83], a[132:135], 0
    ds_read_b64_tr_b16 v[100:101], v14 offset:6208
    v_mfma_f32_16x16x32_bf16 a[40:43], v[84:87], a[132:135], 0
    s_waitcnt vmcnt(5)
    ds_read_b128 a[64:67], v10 offset:4096
    ds_read_b128 a[68:71], v11 offset:4096
    s_waitcnt lgkmcnt(6)
    buffer_load_dwordx4 v26, s[20:23], s65 offen lds
    s_add_u32 m0, s76, 3072
    s_add_u32 s65, s68, 128
    v_mfma_f32_16x16x32_bf16 a[44:47], v[88:91], a[132:135], 0
    ds_read_b64_tr_b16 v[102:103], v14 offset:6976
    v_mfma_f32_16x16x32_bf16 v[104:107], v[80:83], v[20:23], 0
    v_mfma_f32_16x16x32_bf16 v[108:111], v[84:87], v[20:23], 0
    v_mfma_f32_16x16x32_bf16 v[112:115], v[88:91], v[20:23], 0
    buffer_load_dwordx4 v27, s[20:23], s65 offen lds
    s_waitcnt lgkmcnt(0)
    s_add_u32 m0, s76, 4096
    s_add_u32 s65, s68, 128
    v_mfma_f32_16x16x32_bf16 a[0:3], v[92:95], a[136:139], a[0:3]
    v_mfma_f32_16x16x32_bf16 a[4:7], v[96:99], a[136:139], a[4:7]
    ds_read_b64_tr_b16 v[80:81], v14 offset:12288
    v_mfma_f32_16x16x32_bf16 a[8:11], v[100:103], a[136:139], a[8:11]
    s_waitcnt vmcnt(5)
    ds_read_b128 a[72:75], v10 offset:6144
    ds_read_b128 a[76:79], v11 offset:6144
    s_waitcnt lgkmcnt(4)
    buffer_load_dwordx4 v28, s[20:23], s65 offen lds
    s_add_u32 m0, s76, 5120
    s_add_u32 s65, s68, 128
    v_mfma_f32_16x16x32_bf16 a[12:15], v[92:95], a[140:143], a[12:15]
    ds_read_b64_tr_b16 v[82:83], v14 offset:13056
    v_mfma_f32_16x16x32_bf16 a[16:19], v[96:99], a[140:143], a[16:19]
    v_mfma_f32_16x16x32_bf16 a[20:23], v[100:103], a[140:143], a[20:23]
    ds_read_b64_tr_b16 v[84:85], v15 offset:12320
    v_mfma_f32_16x16x32_bf16 a[24:27], v[92:95], a[144:147], a[24:27]
    buffer_load_dwordx4 v29, s[20:23], s65 offen lds
    v_mfma_f32_16x16x32_bf16 a[28:31], v[96:99], a[144:147], a[28:31]
    ds_read_b64_tr_b16 v[86:87], v15 offset:13088
    s_add_u32 m0, s76, 6144
    s_add_u32 s65, s68, 128
    v_mfma_f32_16x16x32_bf16 a[32:35], v[100:103], a[144:147], a[32:35]
    v_mfma_f32_16x16x32_bf16 a[36:39], v[92:95], a[148:151], a[36:39]
    ds_read_b64_tr_b16 v[88:89], v14 offset:12352
    v_mfma_f32_16x16x32_bf16 a[40:43], v[96:99], a[148:151], a[40:43]
    s_waitcnt vmcnt(4)
    ds_read_b128 a[80:83], v10 offset:0
    ds_read_b128 a[84:87], v11 offset:0
    s_waitcnt lgkmcnt(6)
    buffer_load_dwordx4 v30, s[20:23], s65 offen lds
    s_add_u32 m0, s76, 7168
    s_add_u32 s65, s68, 128
    v_mfma_f32_16x16x32_bf16 a[44:47], v[100:103], a[148:151], a[44:47]
    ds_read_b64_tr_b16 v[90:91], v14 offset:13120
    v_mfma_f32_16x16x32_bf16 v[104:107], v[92:95], v[20:23], v[104:107]
    v_mfma_f32_16x16x32_bf16 v[108:111], v[96:99], v[20:23], v[108:111]
    v_mfma_f32_16x16x32_bf16 v[112:115], v[100:103], v[20:23], v[112:115]
    buffer_load_dwordx4 v31, s[20:23], s65 offen lds
    s_waitcnt lgkmcnt(0)
    s_add_u32 m0, s76, 0
    s_add_u32 s65, s68, 256
    v_mfma_f32_16x16x32_bf16 a[0:3], v[80:83], a[152:155], a[0:3]
    v_mfma_f32_16x16x32_bf16 a[4:7], v[84:87], a[152:155], a[4:7]
    ds_read_b64_tr_b16 v[92:93], v14 offset:18432
    v_mfma_f32_16x16x32_bf16 a[8:11], v[88:91], a[152:155], a[8:11]
    s_waitcnt vmcnt(4)
    ds_read_b128 a[88:91], v10 offset:2048
    ds_read_b128 a[92:95], v11 offset:2048
    s_waitcnt lgkmcnt(4)
    buffer_load_dwordx4 v24, s[20:23], s65 offen lds
    s_add_u32 m0, s76, 1024
    s_add_u32 s65, s68, 256
    v_mfma_f32_16x16x32_bf16 a[12:15], v[80:83], a[156:159], a[12:15]
    ds_read_b64_tr_b16 v[94:95], v14 offset:19200
    v_mfma_f32_16x16x32_bf16 a[16:19], v[84:87], a[156:159], a[16:19]
    v_mfma_f32_16x16x32_bf16 a[20:23], v[88:91], a[156:159], a[20:23]
    ds_read_b64_tr_b16 v[96:97], v15 offset:18464
    v_mfma_f32_16x16x32_bf16 a[24:27], v[80:83], a[160:163], a[24:27]
    buffer_load_dwordx4 v25, s[20:23], s65 offen lds
    v_mfma_f32_16x16x32_bf16 a[28:31], v[84:87], a[160:163], a[28:31]
    ds_read_b64_tr_b16 v[98:99], v15 offset:19232
    s_add_u32 m0, s76, 2048
    s_add_u32 s65, s68, 256
    v_mfma_f32_16x16x32_bf16 a[32:35], v[88:91], a[160:163], a[32:35]
    v_mfma_f32_16x16x32_bf16 a[36:39], v[80:83], a[164:167], a[36:39]
    ds_read_b64_tr_b16 v[100:101], v14 offset:18496
    v_mfma_f32_16x16x32_bf16 a[40:43], v[84:87], a[164:167], a[40:43]
    s_waitcnt vmcnt(4)
    ds_read_b128 a[96:99], v10 offset:4096
    ds_read_b128 a[100:103], v11 offset:4096
    s_waitcnt lgkmcnt(6)
    buffer_load_dwordx4 v26, s[20:23], s65 offen lds
    s_add_u32 m0, s76, 3072
    s_add_u32 s65, s68, 256
    v_mfma_f32_16x16x32_bf16 a[44:47], v[88:91], a[164:167], a[44:47]
    ds_read_b64_tr_b16 v[102:103], v14 offset:19264
    v_mfma_f32_16x16x32_bf16 v[104:107], v[80:83], v[20:23], v[104:107]
    v_mfma_f32_16x16x32_bf16 v[108:111], v[84:87], v[20:23], v[108:111]
    v_mfma_f32_16x16x32_bf16 v[112:115], v[88:91], v[20:23], v[112:115]
    buffer_load_dwordx4 v27, s[20:23], s65 offen lds
    s_waitcnt lgkmcnt(0)
    s_add_u32 s85, s93, 1024
    buffer_load_dwordx4 v[152:155], v3, s[32:35], s93 offen sc1
    buffer_load_dwordx4 v[156:159], v3, s[32:35], s85 offen sc1
    v_mfma_f32_16x16x32_bf16 a[0:3], v[92:95], a[168:171], a[0:3]
    v_mfma_f32_16x16x32_bf16 a[4:7], v[96:99], a[168:171], a[4:7]
    ds_read_b64_tr_b16 v[80:81], v14 offset:24576
    v_mfma_f32_16x16x32_bf16 a[8:11], v[100:103], a[168:171], a[8:11]
    s_waitcnt vmcnt(6)
    ds_read_b128 a[104:107], v10 offset:6144
    ds_read_b128 a[108:111], v11 offset:6144
    s_waitcnt vmcnt(4)
    ds_read_b128 a[112:115], v10 offset:0
    ds_read_b128 a[116:119], v11 offset:0
    s_waitcnt vmcnt(2)
    ds_read_b128 a[120:123], v10 offset:2048
    ds_read_b128 a[124:127], v11 offset:2048
    v_mfma_f32_16x16x32_bf16 a[12:15], v[92:95], a[172:175], a[12:15]
    ds_read_b64_tr_b16 v[82:83], v14 offset:25344
    v_mfma_f32_16x16x32_bf16 a[16:19], v[96:99], a[172:175], a[16:19]
    v_mfma_f32_16x16x32_bf16 a[20:23], v[100:103], a[172:175], a[20:23]
    ds_read_b64_tr_b16 v[84:85], v15 offset:24608
    v_mfma_f32_16x16x32_bf16 a[24:27], v[92:95], a[176:179], a[24:27]
    v_mfma_f32_16x16x32_bf16 a[28:31], v[96:99], a[176:179], a[28:31]
    ds_read_b64_tr_b16 v[86:87], v15 offset:25376
    v_mfma_f32_16x16x32_bf16 a[32:35], v[100:103], a[176:179], a[32:35]
    v_mfma_f32_16x16x32_bf16 a[36:39], v[92:95], a[180:183], a[36:39]
    ds_read_b64_tr_b16 v[88:89], v14 offset:24640
    v_mfma_f32_16x16x32_bf16 a[40:43], v[96:99], a[180:183], a[40:43]
    v_mfma_f32_16x16x32_bf16 a[44:47], v[100:103], a[180:183], a[44:47]
    ds_read_b64_tr_b16 v[90:91], v14 offset:25408
    v_mfma_f32_16x16x32_bf16 v[104:107], v[92:95], v[20:23], v[104:107]
    v_mfma_f32_16x16x32_bf16 v[108:111], v[96:99], v[20:23], v[108:111]
    v_mfma_f32_16x16x32_bf16 v[112:115], v[100:103], v[20:23], v[112:115]
    s_mov_b32 s84, 0x4000
    s_waitcnt vmcnt(0)
    s_branch L_pc_chk
L_pc:
    s_add_u32 s85, s93, 1024
    buffer_load_dwordx4 v[152:155], v3, s[32:35], s93 offen sc1
    buffer_load_dwordx4 v[156:159], v3, s[32:35], s85 offen sc1
    s_waitcnt vmcnt(0)
L_pc_chk:
    v_xor_b32 v154, s49, v154
    v_xor_b32 v155, s49, v155
    v_xor_b32 v158, s49, v158
    v_xor_b32 v159, s49, v159
    v_or3_b32 v154, v154, v155, v158
    v_or_b32 v154, v154, v159
    v_cmp_ne_u32 vcc, 0, v154
    s_cbranch_vccz L_pc_ok
    s_sleep 2
    s_sub_u32 s84, s84, 1
    s_cmp_lg_u32 s84, 0
    s_cbranch_scc1 L_pc
L_pc_ok:
    v_add_f32 v152, v152, v156
    v_add_f32 v153, v153, v157
    s_nop 1
    v_permlane32_swap_b32 v152, v153
    v_add_f32 v152, v152, v153
    v_mov_b32 v153, v152
    s_nop 1
    v_permlane16_swap_b32 v152, v153
    v_add_f32 v152, v152, v153
    v_mov_b32 v153, v152
    s_nop 1
    v_permlane32_swap_b32 v152, v153
    v_mul_f32 v152, 0x3aaaaaab, v152
    v_fmac_f32 v196, 0x3aaaaaab, v153
    v_fma_f32 v153, -v152, v152, v196
    v_rsq_f32 v154, v153
    s_nop 0
    v_mul_f32 v155, -v152, v154
    v_pk_fma_f32 v[44:45], v[44:45], v[154:155], v[154:155] op_sel:[0,0,1] op_sel_hi:[1,0,1]
    v_pk_fma_f32 v[46:47], v[46:47], v[154:155], v[154:155] op_sel:[0,0,1] op_sel_hi:[1,0,1]
    v_pk_fma_f32 v[48:49], v[48:49], v[154:155], v[154:155] op_sel:[0,0,1] op_sel_hi:[1,0,1]
    v_pk_fma_f32 v[50:51], v[50:51], v[154:155], v[154:155] op_sel:[0,0,1] op_sel_hi:[1,0,1]
    v_pk_fma_f32 v[52:53], v[52:53], v[154:155], v[154:155] op_sel:[0,0,1] op_sel_hi:[1,0,1]
    v_pk_fma_f32 v[54:55], v[54:55], v[154:155], v[154:155] op_sel:[0,0,1] op_sel_hi:[1,0,1]
    v_pk_fma_f32 v[56:57], v[56:57], v[154:155], v[154:155] op_sel:[0,0,1] op_sel_hi:[1,0,1]
    v_pk_fma_f32 v[58:59], v[58:59], v[154:155], v[154:155] op_sel:[0,0,1] op_sel_hi:[1,0,1]
    v_pk_fma_f32 v[60:61], v[60:61], v[154:155], v[154:155] op_sel:[0,0,1] op_sel_hi:[1,0,1]
    v_pk_fma_f32 v[62:63], v[62:63], v[154:155], v[154:155] op_sel:[0,0,1] op_sel_hi:[1,0,1]
    v_pk_fma_f32 v[64:65], v[64:65], v[154:155], v[154:155] op_sel:[0,0,1] op_sel_hi:[1,0,1]
    v_pk_fma_f32 v[66:67], v[66:67], v[154:155], v[154:155] op_sel:[0,0,1] op_sel_hi:[1,0,1]
    v_mul_u32_u24 v4, 192, v13
    v_lshl_add_u32 v4, v2, 4, v4
    s_mul_i32 s84, s48, 393216
    s_add_u32 s84, s84, 0x400000
    s_bitcmp1_b32 s88, 3
    s_cbranch_scc1 L_z2_sw
    v_cvt_pk_bf16_f32 v152, v44, v45
    v_cvt_pk_bf16_f32 v153, v46, v47
    v_cvt_pk_bf16_f32 v154, v48, v49
    v_cvt_pk_bf16_f32 v155, v50, v51
    v_cvt_pk_bf16_f32 v156, v52, v53
    v_cvt_pk_bf16_f32 v157, v54, v55
    v_cvt_pk_bf16_f32 v158, v56, v57
    v_cvt_pk_bf16_f32 v159, v58, v59
    v_cvt_pk_bf16_f32 v160, v60, v61
    v_cvt_pk_bf16_f32 v161, v62, v63
    v_cvt_pk_bf16_f32 v162, v64, v65
    v_cvt_pk_bf16_f32 v163, v66, v67
    s_branch L_z2_st
L_z2_sw:
    v_cvt_pk_bf16_f32 v152, v48, v49
    v_cvt_pk_bf16_f32 v153, v50, v51
    v_cvt_pk_bf16_f32 v154, v44, v45
    v_cvt_pk_bf16_f32 v155, v46, v47
    v_cvt_pk_bf16_f32 v156, v56, v57
    v_cvt_pk_bf16_f32 v157, v58, v59
    v_cvt_pk_bf16_f32 v158, v52, v53
    v_cvt_pk_bf16_f32 v159, v54, v55
    v_cvt_pk_bf16_f32 v160, v64, v65
    v_cvt_pk_bf16_f32 v161, v66, v67
    v_cvt_pk_bf16_f32 v162, v60, v61
    v_cvt_pk_bf16_f32 v163, v62, v63
L_z2_st:
    buffer_store_dwordx4 v[152:155], v4, s[32:35], s84 offen offset:0 sc1
    buffer_store_dwordx4 v[156:159], v4, s[32:35], s84 offen offset:64 sc1
    buffer_store_dwordx4 v[160:163], v4, s[32:35], s84 offen offset:128 sc1
    s_waitcnt lgkmcnt(0)
    s_waitcnt vmcnt(26) lgkmcnt(0)
    s_barrier
    s_getpc_b64 s[6:7]
L_sequential_preLN__spectral_fnet__mixer_gmlp__prompt_pc_2:
    s_lshl_b32 s84, s44, 13
    v_lshlrev_b32 v6, 7, v0
    v_add_u32 v6, s84, v6
    v_min_u32 v6, L_end-L_sequential_preLN__spectral_fnet__mixer_gmlp__prompt_pc_2, v6
    global_load_dword v247, v6, s[6:7]
    s_and_b32 s84, s48, 3
    s_lshl_b32 s84, s84, 2
    s_lshl_b32 s85, s50, 4
    s_add_u32 s84, s84, s85
    v_add_u32 v6, s84, v2
    v_mul_i32_i24 v6, s89, v6
    v_add_u32 v6, s88, v6
    v_lshlrev_b32 v6, 12, v6
    v_and_b32 v7, 12, v0
    v_lshl_add_u32 v6, v7, 8, v6
    v_and_b32 v7, 3, v0
    v_lshl_add_u32 v6, v7, 7, v6
    s_add_u32 m0, s67, 0
    s_add_u32 s65, s68, 256
    s_mov_b32 exec_lo, 0x33333333
    s_mov_b32 exec_hi, 0x33333333
    buffer_load_dword v247, v6, s[20:23], 0 offen offset:768
    s_mov_b64 exec, -1
    v_mfma_f32_16x16x32_bf16 a[0:3], v[80:83], a[184:187], a[0:3]
    v_mfma_f32_16x16x32_bf16 a[4:7], v[84:87], a[184:187], a[4:7]
    ds_read_b64_tr_b16 v[92:93], v248 offset:0
    v_mfma_f32_16x16x32_bf16 a[8:11], v[88:91], a[184:187], a[8:11]
    buffer_load_dwordx4 v28, s[20:23], s65 offen lds
    v_mfma_f32_16x16x32_bf16 a[12:15], v[80:83], a[188:191], a[12:15]
    ds_read_b64_tr_b16 v[94:95], v248 offset:768
    v_mfma_f32_16x16x32_bf16 a[16:19], v[84:87], a[188:191], a[16:19]
    v_mfma_f32_16x16x32_bf16 a[20:23], v[88:91], a[188:191], a[20:23]
    ds_read_b64_tr_b16 v[96:97], v249 offset:32
    v_mfma_f32_16x16x32_bf16 a[24:27], v[80:83], a[192:195], a[24:27]
    v_mfma_f32_16x16x32_bf16 a[28:31], v[84:87], a[192:195], a[28:31]
    ds_read_b64_tr_b16 v[98:99], v249 offset:800
    v_mfma_f32_16x16x32_bf16 a[32:35], v[88:91], a[192:195], a[32:35]
    v_mfma_f32_16x16x32_bf16 a[36:39], v[80:83], a[196:199], a[36:39]
    ds_read_b64_tr_b16 v[100:101], v248 offset:64
    v_mfma_f32_16x16x32_bf16 a[40:43], v[84:87], a[196:199], a[40:43]
    v_mfma_f32_16x16x32_bf16 a[44:47], v[88:91], a[196:199], a[44:47]
    ds_read_b64_tr_b16 v[102:103], v248 offset:832
    s_add_u32 m0, s67, 1024
    s_add_u32 s65, s68, 256
    v_mfma_f32_16x16x32_bf16 v[104:107], v[80:83], v[20:23], v[104:107]
    v_mfma_f32_16x16x32_bf16 v[108:111], v[84:87], v[20:23], v[108:111]
    v_mfma_f32_16x16x32_bf16 v[112:115], v[88:91], v[20:23], v[112:115]
    s_waitcnt lgkmcnt(0)
    v_mfma_f32_16x16x32_bf16 a[0:3], v[92:95], a[200:203], a[0:3]
    v_mfma_f32_16x16x32_bf16 a[4:7], v[96:99], a[200:203], a[4:7]
    ds_read_b64_tr_b16 v[80:81], v248 offset:6144
    v_mfma_f32_16x16x32_bf16 a[8:11], v[100:103], a[200:203], a[8:11]
    buffer_load_dwordx4 v29, s[20:23], s65 offen lds
    v_mfma_f32_16x16x32_bf16 a[12:15], v[92:95], a[204:207], a[12:15]
    ds_read_b64_tr_b16 v[82:83], v248 offset:6912
    v_mfma_f32_16x16x32_bf16 a[16:19], v[96:99], a[204:207], a[16:19]
    v_mfma_f32_16x16x32_bf16 a[20:23], v[100:103], a[204:207], a[20:23]
    ds_read_b64_tr_b16 v[84:85], v249 offset:6176
    v_mfma_f32_16x16x32_bf16 a[24:27], v[92:95], a[208:211], a[24:27]
    v_mfma_f32_16x16x32_bf16 a[28:31], v[96:99], a[208:211], a[28:31]
    ds_read_b64_tr_b16 v[86:87], v249 offset:6944
    v_mfma_f32_16x16x32_bf16 a[32:35], v[100:103], a[208:211], a[32:35]
    v_mfma_f32_16x16x32_bf16 a[36:39], v[92:95], a[212:215], a[36:39]
    ds_read_b64_tr_b16 v[88:89], v248 offset:6208
    v_mfma_f32_16x16x32_bf16 a[40:43], v[96:99], a[212:215], a[40:43]
    v_mfma_f32_16x16x32_bf16 a[44:47], v[100:103], a[212:215], a[44:47]
    ds_read_b64_tr_b16 v[90:91], v248 offset:6976
    s_add_u32 m0, s67, 2048
    s_add_u32 s65, s68, 256
    v_mfma_f32_16x16x32_bf16 v[104:107], v[92:95], v[20:23], v[104:107]
    v_mfma_f32_16x16x32_bf16 v[108:111], v[96:99], v[20:23], v[108:111]
    v_mfma_f32_16x16x32_bf16 v[112:115], v[100:103], v[20:23], v[112:115]
    s_waitcnt lgkmcnt(0)
    v_mfma_f32_16x16x32_bf16 a[0:3], v[80:83], a[216:219], a[0:3]
    v_mfma_f32_16x16x32_bf16 a[4:7], v[84:87], a[216:219], a[4:7]
    ds_read_b64_tr_b16 v[92:93], v248 offset:12288
    v_mfma_f32_16x16x32_bf16 a[8:11], v[88:91], a[216:219], a[8:11]
    buffer_load_dwordx4 v30, s[20:23], s65 offen lds
    v_mfma_f32_16x16x32_bf16 a[12:15], v[80:83], a[220:223], a[12:15]
    ds_read_b64_tr_b16 v[94:95], v248 offset:13056
    v_mfma_f32_16x16x32_bf16 a[16:19], v[84:87], a[220:223], a[16:19]
    v_mfma_f32_16x16x32_bf16 a[20:23], v[88:91], a[220:223], a[20:23]
    ds_read_b64_tr_b16 v[96:97], v249 offset:12320
    v_mfma_f32_16x16x32_bf16 a[24:27], v[80:83], a[224:227], a[24:27]
    v_mfma_f32_16x16x32_bf16 a[28:31], v[84:87], a[224:227], a[28:31]
    ds_read_b64_tr_b16 v[98:99], v249 offset:13088
    v_mfma_f32_16x16x32_bf16 a[32:35], v[88:91], a[224:227], a[32:35]
    v_mfma_f32_16x16x32_bf16 a[36:39], v[80:83], a[228:231], a[36:39]
    ds_read_b64_tr_b16 v[100:101], v248 offset:12352
    v_mfma_f32_16x16x32_bf16 a[40:43], v[84:87], a[228:231], a[40:43]
    v_mfma_f32_16x16x32_bf16 a[44:47], v[88:91], a[228:231], a[44:47]
    ds_read_b64_tr_b16 v[102:103], v248 offset:13120
    v_mfma_f32_16x16x32_bf16 v[104:107], v[80:83], v[20:23], v[104:107]
    v_mfma_f32_16x16x32_bf16 v[108:111], v[84:87], v[20:23], v[108:111]
    v_mfma_f32_16x16x32_bf16 v[112:115], v[88:91], v[20:23], v[112:115]
    ds_read_b64_tr_b16 v[80:81], v248 offset:18432
    ds_read_b64_tr_b16 v[82:83], v248 offset:19200
    ds_read_b64_tr_b16 v[84:85], v249 offset:18464
    ds_read_b64_tr_b16 v[86:87], v249 offset:19232
    ds_read_b64_tr_b16 v[88:89], v248 offset:18496
    ds_read_b64_tr_b16 v[90:91], v248 offset:19264
    ds_read_b64_tr_b16 v[116:117], v248 offset:24576
    ds_read_b64_tr_b16 v[118:119], v248 offset:25344
    ds_read_b64_tr_b16 v[120:121], v249 offset:24608
    ds_read_b64_tr_b16 v[122:123], v249 offset:25376
    ds_read_b64_tr_b16 v[124:125], v248 offset:24640
    ds_read_b64_tr_b16 v[126:127], v248 offset:25408
    s_waitcnt lgkmcnt(12)
    v_mfma_f32_16x16x32_bf16 v[104:107], v[92:95], v[20:23], v[104:107]
    v_mfma_f32_16x16x32_bf16 v[108:111], v[96:99], v[20:23], v[108:111]
    v_mfma_f32_16x16x32_bf16 v[112:115], v[100:103], v[20:23], v[112:115]
    s_waitcnt lgkmcnt(0)
    v_mfma_f32_16x16x32_bf16 v[104:107], v[80:83], v[20:23], v[104:107]
    v_mfma_f32_16x16x32_bf16 v[108:111], v[84:87], v[20:23], v[108:111]
    v_mfma_f32_16x16x32_bf16 v[112:115], v[88:91], v[20:23], v[112:115]
    s_waitcnt vmcnt(5)
    s_barrier
    s_cmp_lg_u32 s44, 0
    s_cbranch_scc1 L_fd_skip
    s_lshl_b32 s98, s48, 10
    s_lshr_b32 s99, s47, 2
    s_lshl_b32 s99, s99, 7
    s_add_u32 s98, s98, s99
    s_and_b32 s99, s47, 3
    s_lshl_b32 s99, s99, 2
    s_add_u32 s98, s98, s99
    s_add_u32 s98, s98, 0xd10000
    v_mov_b32 v4, s49
    v_mov_b32 v5, 0
    s_mov_b64 exec, 1
    buffer_store_dword v4, v5, s[32:35], s98 offen sc1
    s_mov_b64 exec, -1
L_fd_skip:
    s_add_u32 m0, s67, 3072
    s_add_u32 s65, s68, 256
    v_mfma_f32_16x16x32_bf16 a[12:15], v[92:95], a[236:239], a[12:15]
    v_mfma_f32_16x16x32_bf16 a[16:19], v[96:99], a[236:239], a[16:19]
    v_mfma_f32_16x16x32_bf16 a[20:23], v[100:103], a[236:239], a[20:23]
    v_mfma_f32_16x16x32_bf16 a[12:15], v[80:83], a[252:255], a[12:15]
    buffer_load_dwordx4 v31, s[20:23], s65 offen lds
    s_add_u32 m0, s67, 4096
    s_add_u32 s65, s68, 384
    v_mfma_f32_16x16x32_bf16 a[16:19], v[84:87], a[252:255], a[16:19]
    v_mfma_f32_16x16x32_bf16 a[20:23], v[88:91], a[252:255], a[20:23]
    v_mfma_f32_16x16x32_bf16 a[12:15], v[116:119], v[224:227], a[12:15]
    v_mfma_f32_16x16x32_bf16 a[16:19], v[120:123], v[224:227], a[16:19]
    buffer_load_dwordx4 v24, s[20:23], s65 offen lds
    s_add_u32 m0, s67, 5120
    s_add_u32 s65, s68, 384
    v_mfma_f32_16x16x32_bf16 a[20:23], v[124:127], v[224:227], a[20:23]
    v_mfma_f32_16x16x32_bf16 a[24:27], v[92:95], a[240:243], a[24:27]
    v_mfma_f32_16x16x32_bf16 a[28:31], v[96:99], a[240:243], a[28:31]
    v_mfma_f32_16x16x32_bf16 a[32:35], v[100:103], a[240:243], a[32:35]
    buffer_load_dwordx4 v25, s[20:23], s65 offen lds
    s_add_u32 m0, s67, 6144
    s_add_u32 s65, s68, 384
    v_mfma_f32_16x16x32_bf16 a[24:27], v[80:83], v[212:215], a[24:27]
    v_mfma_f32_16x16x32_bf16 a[28:31], v[84:87], v[212:215], a[28:31]
    ds_write_b128 v201, a[12:15] offset:0
    v_mfma_f32_16x16x32_bf16 a[32:35], v[88:91], v[212:215], a[32:35]
    v_mfma_f32_16x16x32_bf16 a[24:27], v[116:119], v[228:231], a[24:27]
    ds_write_b128 v201, a[16:19] offset:1024
    buffer_load_dwordx4 v26, s[20:23], s65 offen lds
    s_add_u32 m0, s67, 7168
    s_add_u32 s65, s68, 384
    v_mfma_f32_16x16x32_bf16 a[28:31], v[120:123], v[228:231], a[28:31]
    v_mfma_f32_16x16x32_bf16 a[32:35], v[124:127], v[228:231], a[32:35]
    ds_write_b128 v201, a[20:23] offset:2048
    v_mfma_f32_16x16x32_bf16 a[36:39], v[92:95], a[244:247], a[36:39]
    v_mfma_f32_16x16x32_bf16 a[40:43], v[96:99], a[244:247], a[40:43]
    buffer_load_dwordx4 v27, s[20:23], s65 offen lds
    s_add_u32 m0, s67, 8192
    s_add_u32 s65, s68, 384
    v_mfma_f32_16x16x32_bf16 a[44:47], v[100:103], a[244:247], a[44:47]
    v_mfma_f32_16x16x32_bf16 a[36:39], v[80:83], v[216:219], a[36:39]
    v_mfma_f32_16x16x32_bf16 a[40:43], v[84:87], v[216:219], a[40:43]
    ds_write_b128 v202, a[24:27] offset:0
    v_mfma_f32_16x16x32_bf16 a[44:47], v[88:91], v[216:219], a[44:47]
    buffer_load_dwordx4 v28, s[20:23], s65 offen lds
    s_add_u32 m0, s67, 9216
    s_add_u32 s65, s68, 384
    v_mfma_f32_16x16x32_bf16 a[36:39], v[116:119], v[232:235], a[36:39]
    ds_write_b128 v202, a[28:31] offset:1024
    v_mfma_f32_16x16x32_bf16 a[40:43], v[120:123], v[232:235], a[40:43]
    v_mfma_f32_16x16x32_bf16 a[44:47], v[124:127], v[232:235], a[44:47]
    ds_write_b128 v202, a[32:35] offset:2048
    v_mfma_f32_16x16x32_bf16 a[0:3], v[92:95], a[232:235], a[0:3]
    buffer_load_dwordx4 v29, s[20:23], s65 offen lds
    s_add_u32 m0, s67, 10240
    s_add_u32 s65, s68, 384
    v_mfma_f32_16x16x32_bf16 a[4:7], v[96:99], a[232:235], a[4:7]
    v_mfma_f32_16x16x32_bf16 a[8:11], v[100:103], a[232:235], a[8:11]
    v_mfma_f32_16x16x32_bf16 a[0:3], v[80:83], a[248:251], a[0:3]
    v_mfma_f32_16x16x32_bf16 a[4:7], v[84:87], a[248:251], a[4:7]
    ds_write_b128 v203, a[36:39] offset:0
    s_waitcnt vmcnt(8)
    ds_read_b128 a[128:131], v8 offset:0
    ds_read_b128 a[132:135], v9 offset:0
    buffer_load_dwordx4 v30, s[20:23], s65 offen lds
    s_add_u32 m0, s67, 11264
    s_add_u32 s65, s68, 384
    v_mfma_f32_16x16x32_bf16 a[8:11], v[88:91], a[248:251], a[8:11]
    v_mfma_f32_16x16x32_bf16 a[0:3], v[116:119], v[220:223], a[0:3]
    ds_write_b128 v203, a[40:43] offset:1024
    v_mfma_f32_16x16x32_bf16 a[4:7], v[120:123], v[220:223], a[4:7]
    v_mfma_f32_16x16x32_bf16 a[8:11], v[124:127], v[220:223], a[8:11]
    ds_write_b128 v203, a[44:47] offset:2048
    buffer_load_dwordx4 v31, s[20:23], s65 offen lds
    s_add_u32 m0, s67, 12288
    s_add_u32 s65, s68, 512
    v_mfma_f32_16x16x32_bf16 v[104:107], v[116:119], v[20:23], v[104:107]
    v_mfma_f32_16x16x32_bf16 v[108:111], v[120:123], v[20:23], v[108:111]
    v_mfma_f32_16x16x32_bf16 v[112:115], v[124:127], v[20:23], v[112:115]
    s_waitcnt vmcnt(8)
    ds_read_b128 a[136:139], v8 offset:2048
    ds_read_b128 a[140:143], v9 offset:2048
    buffer_load_dwordx4 v24, s[20:23], s65 offen lds
    s_mul_i32 s52, s44, 192
    s_add_u32 s52, s52, 79872
    v_add_u32 v4, s52, v0
    s_nop 4
    s_mov_b32 exec_lo, 0x00010001
    s_mov_b32 exec_hi, 0x00010001
    ds_write_b128 v4, v[104:107] offset:0
    ds_write_b128 v4, v[108:111] offset:64
    ds_write_b128 v4, v[112:115] offset:128
    s_mov_b64 exec, -1
    s_waitcnt lgkmcnt(0)
    s_barrier
    ds_read_b128 v[152:155], v200 offset:0
    ds_read_b128 v[156:159], v200 offset:1024
    ds_read_b128 v[160:163], v200 offset:2048
    ds_read_b128 v[164:167], v200 offset:3072
    ds_read_b128 v[168:171], v200 offset:4096
    ds_read_b128 v[172:175], v200 offset:5120
    ds_read_b128 v[176:179], v200 offset:6144
    ds_read_b128 v[180:183], v200 offset:7168
    ds_read_b128 v[184:187], v200 offset:8192
    s_waitcnt lgkmcnt(3)
    v_lshlrev_b32 v4, 4, v2
    v_add_u32 v4, 79872, v4
    ds_read_b128 v[80:83], v4 offset:0
    ds_read_b128 v[84:87], v4 offset:64
    ds_read_b128 v[88:91], v4 offset:128
    ds_read_b128 v[104:107], v4 offset:192
    s_add_u32 m0, s67, 13312
    s_add_u32 s65, s68, 512
    ds_read_b128 v[108:111], v4 offset:256
    ds_read_b128 v[112:115], v4 offset:320
    ds_read_b128 v[92:95], v4 offset:384
    ds_read_b128 v[96:99], v4 offset:448
    ds_read_b128 v[100:103], v4 offset:512
    ds_read_b128 v[116:119], v4 offset:576
    ds_read_b128 v[120:123], v4 offset:640
    ds_read_b128 v[124:127], v4 offset:704
    buffer_load_dwordx4 v25, s[20:23], s65 offen lds
    s_add_u32 m0, s67, 0
    s_add_u32 s65, s68, 512
    s_waitcnt vmcnt(8)
    ds_read_b128 a[144:147], v8 offset:4096
    ds_read_b128 a[148:151], v9 offset:4096
    s_waitcnt lgkmcnt(15)
    buffer_load_dwordx4 v26, s[20:23], s65 offen lds
    s_add_u32 m0, s67, 1024
    s_add_u32 s65, s68, 512
    buffer_load_dwordx4 v27, s[20:23], s65 offen lds
    s_add_u32 m0, s67, 2048
    s_add_u32 s65, s68, 512
    s_waitcnt vmcnt(8)
    ds_read_b128 a[152:155], v8 offset:6144
    ds_read_b128 a[156:159], v9 offset:6144
    s_waitcnt lgkmcnt(15)
    buffer_load_dwordx4 v28, s[20:23], s65 offen lds
    v_accvgpr_read_b32 v32, a0
    v_accvgpr_read_b32 v33, a1
    v_accvgpr_read_b32 v34, a2
    v_accvgpr_read_b32 v35, a3
    v_accvgpr_read_b32 v36, a4
    v_accvgpr_read_b32 v37, a5
    v_accvgpr_read_b32 v38, a6
    v_accvgpr_read_b32 v39, a7
    v_accvgpr_read_b32 v40, a8
    v_accvgpr_read_b32 v41, a9
    v_accvgpr_read_b32 v42, a10
    v_accvgpr_read_b32 v43, a11
    s_cmp_eq_u32 s51, 0
    s_cbranch_scc0 L_x1_b
    s_waitcnt lgkmcnt(0)
    v_pk_add_f32 v[44:45], v[32:33], v[152:153]
    v_pk_add_f32 v[46:47], v[34:35], v[154:155]
    v_pk_add_f32 v[48:49], v[36:37], v[156:157]
    v_pk_add_f32 v[50:51], v[38:39], v[158:159]
    v_pk_add_f32 v[52:53], v[40:41], v[160:161]
    v_pk_add_f32 v[54:55], v[42:43], v[162:163]
    v_pk_add_f32 v[56:57], v[164:165], v[176:177]
    v_pk_add_f32 v[58:59], v[166:167], v[178:179]
    v_pk_add_f32 v[60:61], v[168:169], v[180:181]
    v_pk_add_f32 v[62:63], v[170:171], v[182:183]
    v_pk_add_f32 v[64:65], v[172:173], v[184:185]
    v_pk_add_f32 v[66:67], v[174:175], v[186:187]
    s_branch L_x1_d
L_x1_b:
    s_waitcnt lgkmcnt(0)
    v_pk_add_f32 v[56:57], v[32:33], v[152:153]
    v_pk_add_f32 v[58:59], v[34:35], v[154:155]
    v_pk_add_f32 v[60:61], v[36:37], v[156:157]
    v_pk_add_f32 v[62:63], v[38:39], v[158:159]
    v_pk_add_f32 v[64:65], v[40:41], v[160:161]
    v_pk_add_f32 v[66:67], v[42:43], v[162:163]
    v_pk_add_f32 v[44:45], v[164:165], v[176:177]
    v_pk_add_f32 v[46:47], v[166:167], v[178:179]
    v_pk_add_f32 v[48:49], v[168:169], v[180:181]
    v_pk_add_f32 v[50:51], v[170:171], v[182:183]
    v_pk_add_f32 v[52:53], v[172:173], v[184:185]
    v_pk_add_f32 v[54:55], v[174:175], v[186:187]
L_x1_d:
    s_add_u32 m0, s67, 3072
    s_add_u32 s65, s68, 512
    v_lshlrev_b32 v4, 1, v13
    buffer_load_ushort v33, v4, s[40:43], 0 offen
    v_mov_b32 v32, v193
    buffer_load_dwordx4 v29, s[20:23], s65 offen lds
    s_mul_i32 s56, s44, 24576
    s_add_u32 s56, s56, 65536
    v_lshrrev_b32 v4, 2, v1
    v_lshl_add_u32 v4, v2, 3, v4
    s_add_u32 m0, s67, 4096
    s_add_u32 s65, s68, 512
    v_mul_u32_u24 v4, 192, v4
    v_and_b32 v5, 3, v1
    v_lshl_add_u32 v4, v5, 4, v4
    v_and_b32 v5, 1, v2
    s_waitcnt vmcnt(9)
    ds_read_b128 a[160:163], v8 offset:8192
    ds_read_b128 a[164:167], v9 offset:8192
    s_waitcnt lgkmcnt(4)
    buffer_load_dwordx4 v30, s[20:23], s65 offen lds
    s_add_u32 m0, s67, 5120
    s_add_u32 s65, s68, 512
    v_lshl_add_u32 v4, v5, 3, v4
    v_add_u32 v16, s56, v4
    v_xor_b32 v17, 8, v16
    s_xor_b32 s84, s44, 1
    s_mul_i32 s84, s84, 24576
    s_add_u32 s84, s84, 65536
    v_add_u32 v18, s84, v3
    s_xor_b32 s84, s44, 2
    buffer_load_dwordx4 v31, s[20:23], s65 offen lds
    s_mul_i32 s84, s84, 24576
    s_add_u32 s84, s84, 68608
    v_add_u32 v19, s84, v3
    s_xor_b32 s84, s44, 3
    s_add_u32 m0, s67, 6144
    s_add_u32 s65, s68, 640
    s_mul_i32 s84, s84, 24576
    s_add_u32 s84, s84, 71680
    v_add_u32 v35, s84, v3
    s_mul_i32 s84, s44, 24576
    s_waitcnt vmcnt(9)
    ds_read_b128 a[168:171], v8 offset:10240
    ds_read_b128 a[172:175], v9 offset:10240
    s_waitcnt lgkmcnt(4)
    buffer_load_dwordx4 v24, s[20:23], s65 offen lds
    s_add_u32 s84, s84, 65536
    v_add_u32 v34, s84, v3
    s_lshl_b32 s82, s48, 6
    s_lshl_b32 s83, s44, 4
    s_add_u32 s82, s82, s83
    s_mul_i32 s82, s82, 6144
    s_add_u32 s82, s82, 0x400000
    s_add_u32 s83, s82, 98304
    v_lshlrev_b32 v12, 7, v0
    s_lshl_b32 s77, s48, 10
    s_add_u32 s77, s77, 0xd10000
    s_cmp_lg_u32 s44, 0
    s_cbranch_scc1 L_pd0
    s_mov_b64 exec, 0xff
    buffer_load_dwordx4 v[36:39], v12, s[32:35], s77 offen sc1
    s_mov_b64 exec, -1
L_pd0:
    s_add_u32 m0, s67, 7168
    s_add_u32 s65, s68, 640
    buffer_load_dwordx4 v25, s[20:23], s65 offen lds
    v_pk_add_f32 v[80:81], v[80:81], v[104:105]
    v_pk_add_f32 v[82:83], v[82:83], v[106:107]
    v_pk_add_f32 v[84:85], v[84:85], v[108:109]
    v_pk_add_f32 v[86:87], v[86:87], v[110:111]
    v_pk_add_f32 v[88:89], v[88:89], v[112:113]
    v_pk_add_f32 v[90:91], v[90:91], v[114:115]
    s_add_u32 m0, s67, 8192
    s_add_u32 s65, s68, 640
    v_pk_add_f32 v[92:93], v[92:93], v[116:117]
    v_pk_add_f32 v[94:95], v[94:95], v[118:119]
    v_pk_add_f32 v[96:97], v[96:97], v[120:121]
    v_pk_add_f32 v[98:99], v[98:99], v[122:123]
    s_waitcnt vmcnt(9)
    ds_read_b128 a[176:179], v8 offset:12288
    ds_read_b128 a[180:183], v9 offset:12288
    s_waitcnt lgkmcnt(4)
    buffer_load_dwordx4 v26, s[20:23], s65 offen lds
    v_pk_add_f32 v[100:101], v[100:101], v[124:125]
    v_pk_add_f32 v[102:103], v[102:103], v[126:127]
    s_add_u32 m0, s67, 9216
    s_add_u32 s65, s68, 640
    s_movk_i32 s84, 0x199a
    s_movk_i32 s85, 1280
    v_add_u32 v4, 0, v0
    v_mul_u32_u24 v5, s84, v4
    v_lshrrev_b32 v5, 16, v5
    v_mul_u32_u24 v6, 10, v5
    v_sub_u32 v4, v4, v6
    v_lshlrev_b32 v4, 4, v4
    buffer_load_dwordx4 v27, s[20:23], s65 offen lds
    v_mad_u32_u24 v232, v5, s85, v4
    v_add_u32 v4, 64, v0
    v_mul_u32_u24 v5, s84, v4
    v_lshrrev_b32 v5, 16, v5
    v_mul_u32_u24 v6, 10, v5
    v_sub_u32 v4, v4, v6
    s_add_u32 m0, s67, 10240
    s_add_u32 s65, s68, 640
    v_lshlrev_b32 v4, 4, v4
    v_mad_u32_u24 v233, v5, s85, v4
    v_add_u32 v4, 128, v0
    v_mul_u32_u24 v5, s84, v4
    s_waitcnt vmcnt(9)
    ds_read_b128 a[184:187], v8 offset:0
    ds_read_b128 a[188:191], v9 offset:0
    s_waitcnt lgkmcnt(4)
    buffer_load_dwordx4 v28, s[20:23], s65 offen lds
    v_lshrrev_b32 v5, 16, v5
    v_mul_u32_u24 v6, 10, v5
    s_add_u32 m0, s67, 11264
    s_add_u32 s65, s68, 640
    v_sub_u32 v4, v4, v6
    v_lshlrev_b32 v4, 4, v4
    v_mad_u32_u24 v234, v5, s85, v4
    v_add_u32 v4, 192, v0
    v_mul_u32_u24 v5, s84, v4
    v_lshrrev_b32 v5, 16, v5
    v_mul_u32_u24 v6, 10, v5
    v_sub_u32 v4, v4, v6
    buffer_load_dwordx4 v29, s[20:23], s65 offen lds
    v_lshlrev_b32 v4, 4, v4
    v_mad_u32_u24 v235, v5, s85, v4
    v_add_u32 v4, 256, v0
    v_mul_u32_u24 v5, s84, v4
    v_lshrrev_b32 v5, 16, v5
    v_mul_u32_u24 v6, 10, v5
    s_add_u32 m0, s67, 12288
    s_add_u32 s65, s68, 640
    v_sub_u32 v4, v4, v6
    v_lshlrev_b32 v4, 4, v4
    v_mad_u32_u24 v238, v5, s85, v4
    s_mul_i32 s54, s51, 12
    s_waitcnt vmcnt(8)
    ds_read_b128 a[192:195], v8 offset:2048
    ds_read_b128 a[196:199], v9 offset:2048
    s_waitcnt lgkmcnt(4)
    buffer_load_dwordx4 v30, s[20:23], s65 offen lds
    s_mul_i32 s55, s50, 3
    s_add_u32 s54, s54, s55
    s_add_u32 m0, s67, 13312
    s_add_u32 s65, s68, 640
    s_mul_i32 s54, s54, 40960
    s_mul_i32 s55, s48, 160
    s_add_u32 s54, s54, s55
    s_mul_i32 s55, s44, 15360
    v_lshrrev_b32 v4, 2, v1
    v_lshl_add_u32 v4, v2, 2, v4
    v_mul_u32_u24 v4, 160, v4
    v_and_b32 v5, 3, v1
    buffer_load_dwordx4 v31, s[20:23], s65 offen lds
    v_lshl_add_u32 v6, v5, 4, v4
    v_lshl_add_u32 v7, v5, 3, v4
    s_mul_i32 s84, s50, 30720
    s_add_u32 s85, s84, 61440
    s_add_u32 m0, s67, 0
    s_add_u32 s65, s68, 768
    v_add_u32 v239, s84, v6
    v_add_u32 v240, s84, v7
    v_add_u32 v241, s85, v6
    v_add_u32 v248, s85, v7
    s_waitcnt vmcnt(8)
    ds_read_b128 a[200:203], v8 offset:4096
    ds_read_b128 a[204:207], v9 offset:4096
    s_waitcnt lgkmcnt(4)
    buffer_load_dwordx4 v24, s[20:23], s65 offen lds
    s_add_u32 m0, s67, 1024
    s_add_u32 s65, s68, 768
    buffer_load_dwordx4 v25, s[20:23], s65 offen lds
    s_add_u32 m0, s67, 2048
    s_add_u32 s65, s68, 768
    s_waitcnt vmcnt(8)
    ds_read_b128 a[208:211], v8 offset:6144
    ds_read_b128 a[212:215], v9 offset:6144
    s_waitcnt lgkmcnt(4)
    buffer_load_dwordx4 v26, s[20:23], s65 offen lds
    s_cmp_lg_u32 s44, 0
    s_cbranch_scc1 L_pd_skip
    s_mov_b64 exec, 0xff
    s_mov_b32 s84, 0x4000
    s_waitcnt vmcnt(10)
    s_branch L_pd_chk
L_pd:
    buffer_load_dwordx4 v[36:39], v12, s[32:35], s77 offen sc1
    s_waitcnt vmcnt(0)
L_pd_chk:
    v_xor_b32 v36, s49, v36
    v_xor_b32 v37, s49, v37
    v_xor_b32 v38, s49, v38
    v_xor_b32 v39, s49, v39
    v_or3_b32 v36, v36, v37, v38
    v_or_b32 v36, v36, v39
    v_cmp_ne_u32 vcc, 0, v36
    s_cbranch_vccz L_pd_ok
    s_sleep 2
    s_sub_u32 s84, s84, 1
    s_cmp_lg_u32 s84, 0
    s_cbranch_scc1 L_pd
L_pd_ok:
    s_mov_b64 exec, -1
L_pd_skip:
    s_add_u32 m0, s56, 0
    s_add_u32 s53, s82, 0
    s_waitcnt lgkmcnt(0)
    s_barrier
    buffer_load_dwordx4 v3, s[32:35], s53 offen sc1 lds
    buffer_load_dwordx4 v3, s[32:35], s53 offen offset:1024 sc1 lds
    buffer_load_dwordx4 v3, s[32:35], s53 offen offset:2048 sc1 lds
    buffer_load_dwordx4 v3, s[32:35], s53 offen offset:3072 sc1 lds
    s_add_u32 m0, m0, 4096
    s_add_u32 s53, s53, 4096
    buffer_load_dwordx4 v3, s[32:35], s53 offen sc1 lds
    buffer_load_dwordx4 v3, s[32:35], s53 offen offset:1024 sc1 lds
    v_pk_fma_f32 v[44:45], v[80:81], v[192:193], v[44:45] op_sel_hi:[1,0,1]
    v_pk_fma_f32 v[46:47], v[82:83], v[192:193], v[46:47] op_sel_hi:[1,0,1]
    v_pk_fma_f32 v[48:49], v[84:85], v[192:193], v[48:49] op_sel_hi:[1,0,1]
    v_pk_fma_f32 v[50:51], v[86:87], v[192:193], v[50:51] op_sel_hi:[1,0,1]
    v_pk_fma_f32 v[52:53], v[88:89], v[192:193], v[52:53] op_sel_hi:[1,0,1]
    v_pk_fma_f32 v[54:55], v[90:91], v[192:193], v[54:55] op_sel_hi:[1,0,1]
    v_pk_fma_f32 v[56:57], v[92:93], v[192:193], v[56:57] op_sel_hi:[1,0,1]
    v_pk_fma_f32 v[58:59], v[94:95], v[192:193], v[58:59] op_sel_hi:[1,0,1]
    v_pk_fma_f32 v[60:61], v[96:97], v[192:193], v[60:61] op_sel_hi:[1,0,1]
    v_pk_fma_f32 v[62:63], v[98:99], v[192:193], v[62:63] op_sel_hi:[1,0,1]
    v_pk_fma_f32 v[64:65], v[100:101], v[192:193], v[64:65] op_sel_hi:[1,0,1]
    v_pk_fma_f32 v[66:67], v[102:103], v[192:193], v[66:67] op_sel_hi:[1,0,1]
    v_pk_mul_f32 v[104:105], v[44:45], v[44:45]
    v_pk_mul_f32 v[106:107], v[46:47], v[46:47]
    v_pk_mul_f32 v[108:109], v[48:49], v[48:49]
    v_pk_mul_f32 v[110:111], v[50:51], v[50:51]
    v_pk_mul_f32 v[112:113], v[52:53], v[52:53]
    v_pk_mul_f32 v[114:115], v[54:55], v[54:55]
    v_pk_mul_f32 v[116:117], v[56:57], v[56:57]
    v_pk_mul_f32 v[118:119], v[58:59], v[58:59]
    v_pk_mul_f32 v[120:121], v[60:61], v[60:61]
    v_pk_mul_f32 v[122:123], v[62:63], v[62:63]
    s_add_u32 m0, s56, 6144
    s_add_u32 s53, s82, 6144
    v_pk_mul_f32 v[124:125], v[64:65], v[64:65]
    v_pk_mul_f32 v[126:127], v[66:67], v[66:67]
    v_pk_fma_f32 v[104:105], v[104:105], v[194:195], v[194:195] op_sel:[0,1,0] op_sel_hi:[1,1,0]
    v_pk_fma_f32 v[106:107], v[106:107], v[194:195], v[194:195] op_sel:[0,1,0] op_sel_hi:[1,1,0]
    v_pk_fma_f32 v[108:109], v[108:109], v[194:195], v[194:195] op_sel:[0,1,0] op_sel_hi:[1,1,0]
    v_pk_fma_f32 v[110:111], v[110:111], v[194:195], v[194:195] op_sel:[0,1,0] op_sel_hi:[1,1,0]
    v_pk_fma_f32 v[112:113], v[112:113], v[194:195], v[194:195] op_sel:[0,1,0] op_sel_hi:[1,1,0]
    v_pk_fma_f32 v[114:115], v[114:115], v[194:195], v[194:195] op_sel:[0,1,0] op_sel_hi:[1,1,0]
    buffer_load_dwordx4 v3, s[32:35], s53 offen sc1 lds
    v_pk_fma_f32 v[116:117], v[116:117], v[194:195], v[194:195] op_sel:[0,1,0] op_sel_hi:[1,1,0]
    v_pk_fma_f32 v[118:119], v[118:119], v[194:195], v[194:195] op_sel:[0,1,0] op_sel_hi:[1,1,0]
    v_pk_fma_f32 v[120:121], v[120:121], v[194:195], v[194:195] op_sel:[0,1,0] op_sel_hi:[1,1,0]
    v_pk_fma_f32 v[122:123], v[122:123], v[194:195], v[194:195] op_sel:[0,1,0] op_sel_hi:[1,1,0]
    v_pk_fma_f32 v[124:125], v[124:125], v[194:195], v[194:195] op_sel:[0,1,0] op_sel_hi:[1,1,0]
    buffer_load_dwordx4 v3, s[32:35], s53 offen offset:1024 sc1 lds
    v_pk_fma_f32 v[126:127], v[126:127], v[194:195], v[194:195] op_sel:[0,1,0] op_sel_hi:[1,1,0]
    v_pk_mul_f32 v[104:105], v[104:105], v[44:45]
    v_pk_mul_f32 v[106:107], v[106:107], v[46:47]
    v_pk_mul_f32 v[108:109], v[108:109], v[48:49]
    v_pk_mul_f32 v[110:111], v[110:111], v[50:51]
    buffer_load_dwordx4 v3, s[32:35], s53 offen offset:2048 sc1 lds
    v_pk_mul_f32 v[112:113], v[112:113], v[52:53]
    v_pk_mul_f32 v[114:115], v[114:115], v[54:55]
    v_pk_mul_f32 v[116:117], v[116:117], v[56:57]
    v_pk_mul_f32 v[118:119], v[118:119], v[58:59]
    v_pk_mul_f32 v[120:121], v[120:121], v[60:61]
    buffer_load_dwordx4 v3, s[32:35], s53 offen offset:3072 sc1 lds
    s_add_u32 m0, m0, 4096
    s_add_u32 s53, s53, 4096
    v_pk_mul_f32 v[122:123], v[122:123], v[62:63]
    v_pk_mul_f32 v[124:125], v[124:125], v[64:65]
    v_pk_mul_f32 v[126:127], v[126:127], v[66:67]
    v_exp_f32 v104, v104
    v_exp_f32 v105, v105
    buffer_load_dwordx4 v3, s[32:35], s53 offen sc1 lds
    v_exp_f32 v106, v106
    v_exp_f32 v107, v107
    v_exp_f32 v108, v108
    v_exp_f32 v109, v109
    v_exp_f32 v110, v110
    buffer_load_dwordx4 v3, s[32:35], s53 offen offset:1024 sc1 lds
    s_add_u32 m0, s56, 12288
    s_add_u32 s53, s82, 12288
    v_exp_f32 v111, v111
    v_exp_f32 v112, v112
    v_exp_f32 v113, v113
    v_exp_f32 v114, v114
    v_exp_f32 v115, v115
    buffer_load_dwordx4 v3, s[32:35], s53 offen sc1 lds
    v_exp_f32 v116, v116
    v_exp_f32 v117, v117
    v_exp_f32 v118, v118
    v_exp_f32 v119, v119
    v_exp_f32 v120, v120
    buffer_load_dwordx4 v3, s[32:35], s53 offen offset:1024 sc1 lds
    v_exp_f32 v121, v121
    v_exp_f32 v122, v122
    v_exp_f32 v123, v123
    v_exp_f32 v124, v124
    v_exp_f32 v125, v125
    buffer_load_dwordx4 v3, s[32:35], s53 offen offset:2048 sc1 lds
    v_exp_f32 v126, v126
    v_exp_f32 v127, v127
    v_pk_add_f32 v[104:105], v[104:105], 1.0 op_sel_hi:[1,0]
    v_pk_add_f32 v[106:107], v[106:107], 1.0 op_sel_hi:[1,0]
    v_pk_add_f32 v[108:109], v[108:109], 1.0 op_sel_hi:[1,0]
    buffer_load_dwordx4 v3, s[32:35], s53 offen offset:3072 sc1 lds
    s_add_u32 m0, m0, 4096
    s_add_u32 s53, s53, 4096
    v_pk_add_f32 v[110:111], v[110:111], 1.0 op_sel_hi:[1,0]
    v_pk_add_f32 v[112:113], v[112:113], 1.0 op_sel_hi:[1,0]
    v_pk_add_f32 v[114:115], v[114:115], 1.0 op_sel_hi:[1,0]
    v_pk_add_f32 v[116:117], v[116:117], 1.0 op_sel_hi:[1,0]
    v_pk_add_f32 v[118:119], v[118:119], 1.0 op_sel_hi:[1,0]
    buffer_load_dwordx4 v3, s[32:35], s53 offen sc1 lds
    v_pk_add_f32 v[120:121], v[120:121], 1.0 op_sel_hi:[1,0]
    v_pk_add_f32 v[122:123], v[122:123], 1.0 op_sel_hi:[1,0]
    v_pk_add_f32 v[124:125], v[124:125], 1.0 op_sel_hi:[1,0]
    v_pk_add_f32 v[126:127], v[126:127], 1.0 op_sel_hi:[1,0]
    v_rcp_f32 v104, v104
    buffer_load_dwordx4 v3, s[32:35], s53 offen offset:1024 sc1 lds
    v_rcp_f32 v105, v105
    v_rcp_f32 v106, v106
    v_rcp_f32 v107, v107
    v_rcp_f32 v108, v108
    v_rcp_f32 v109, v109
    v_rcp_f32 v110, v110
    v_rcp_f32 v111, v111
    v_rcp_f32 v112, v112
    v_rcp_f32 v113, v113
    v_rcp_f32 v114, v114
    v_rcp_f32 v115, v115
    v_rcp_f32 v116, v116
    v_rcp_f32 v117, v117
    v_rcp_f32 v118, v118
    v_rcp_f32 v119, v119
    v_rcp_f32 v120, v120
    v_rcp_f32 v121, v121
    v_rcp_f32 v122, v122
    v_rcp_f32 v123, v123
    v_rcp_f32 v124, v124
    v_rcp_f32 v125, v125
    v_rcp_f32 v126, v126
    v_rcp_f32 v127, v127
    v_pk_mul_f32 v[44:45], v[44:45], v[104:105]
    v_pk_mul_f32 v[46:47], v[46:47], v[106:107]
    v_pk_mul_f32 v[48:49], v[48:49], v[108:109]
    v_pk_mul_f32 v[50:51], v[50:51], v[110:111]
    v_pk_mul_f32 v[52:53], v[52:53], v[112:113]
    v_pk_mul_f32 v[54:55], v[54:55], v[114:115]
    v_pk_mul_f32 v[56:57], v[56:57], v[116:117]
    v_pk_mul_f32 v[58:59], v[58:59], v[118:119]
    v_pk_mul_f32 v[60:61], v[60:61], v[120:121]
    v_pk_mul_f32 v[62:63], v[62:63], v[122:123]
    v_pk_mul_f32 v[64:65], v[64:65], v[124:125]
    v_pk_mul_f32 v[66:67], v[66:67], v[126:127]
    s_cmp_ge_u32 s48, 4
    s_cbranch_scc1 L_hu_m
    v_lshlrev_b32 v212, 16, v128
    v_and_b32 v213, s58, v128
    v_lshlrev_b32 v214, 16, v129
    v_and_b32 v215, s58, v129
    v_lshlrev_b32 v216, 16, v130
    v_and_b32 v217, s58, v130
    v_lshlrev_b32 v218, 16, v131
    v_and_b32 v219, s58, v131
    v_lshlrev_b32 v220, 16, v132
    v_and_b32 v221, s58, v132
    v_lshlrev_b32 v222, 16, v133
    v_and_b32 v223, s58, v133
    v_lshlrev_b32 v224, 16, v134
    v_and_b32 v225, s58, v134
    v_lshlrev_b32 v226, 16, v135
    v_and_b32 v227, s58, v135
    v_lshlrev_b32 v228, 16, v136
    v_and_b32 v229, s58, v136
    v_lshlrev_b32 v230, 16, v137
    v_and_b32 v231, s58, v137
    s_cmp_eq_u32 s48, 0
    s_cselect_b64 vcc, s[86:87], 0
    v_lshlrev_b32 v4, 16, v138
    v_cndmask_b32 v212, v212, v4, vcc
    s_branch L_hu_d
L_hu_m:
    v_lshlrev_b32 v212, 16, v138
    v_and_b32 v213, s58, v131
    v_lshlrev_b32 v214, 16, v131
    v_and_b32 v215, s58, v130
    v_lshlrev_b32 v216, 16, v130
    v_and_b32 v217, s58, v129
    v_lshlrev_b32 v218, 16, v129
    v_and_b32 v219, s58, v128
    v_lshlrev_b32 v220, 16, v139
    v_and_b32 v221, s58, v135
    v_lshlrev_b32 v222, 16, v135
    v_and_b32 v223, s58, v134
    v_lshlrev_b32 v224, 16, v134
    v_and_b32 v225, s58, v133
    v_lshlrev_b32 v226, 16, v133
    v_and_b32 v227, s58, v132
    v_lshlrev_b32 v228, 16, v140
    v_and_b32 v229, s58, v137
    v_lshlrev_b32 v230, 16, v137
    v_and_b32 v231, s58, v136
L_hu_d:
    s_waitcnt vmcnt(32)
    v_lshlrev_b32 v33, 16, v33
    v_mul_f32 v33, v32, v33
    s_waitcnt vmcnt(12)
    ds_read_b64_tr_b16 v[164:165], v16 offset:0
    ds_read_b64_tr_b16 v[166:167], v16 offset:768
    ds_read_b64_tr_b16 v[168:169], v17 offset:0
    ds_read_b64_tr_b16 v[170:171], v17 offset:768
    ds_read_b64_tr_b16 v[172:173], v16 offset:64
    ds_read_b64_tr_b16 v[174:175], v16 offset:832
    ds_read_b64_tr_b16 v[176:177], v17 offset:64
    ds_read_b64_tr_b16 v[178:179], v17 offset:832
    s_add_u32 m0, s56, 18432
    s_add_u32 s53, s82, 18432
    ds_read_b64_tr_b16 v[180:181], v16 offset:128
    ds_read_b64_tr_b16 v[182:183], v16 offset:896
    ds_read_b64_tr_b16 v[184:185], v17 offset:128
    ds_read_b64_tr_b16 v[186:187], v17 offset:896
    s_waitcnt vmcnt(6) lgkmcnt(0)
    v_mfma_f32_16x16x32_bf16 v[68:71], v[164:167], a[48:51], 0
    ds_read_b64_tr_b16 v[188:189], v16 offset:6144
    v_mfma_f32_16x16x32_bf16 v[92:95], v[164:167], a[56:59], 0
    buffer_load_dwordx4 v3, s[32:35], s53 offen sc1 lds
    s_add_u32 m0, s56, 19456
    s_add_u32 s53, s82, 19456
    v_mfma_f32_16x16x32_bf16 v[116:119], v[164:167], a[64:67], 0
    ds_read_b64_tr_b16 v[190:191], v16 offset:6912
    v_mfma_f32_16x16x32_bf16 v[140:143], v[164:167], a[72:75], 0
    buffer_load_dwordx4 v3, s[32:35], s53 offen sc1 lds
    s_add_u32 m0, s56, 20480
    s_add_u32 s53, s82, 20480
    buffer_load_dwordx4 v3, s[32:35], s53 offen sc1 lds
    s_add_u32 m0, s56, 21504
    s_add_u32 s53, s82, 21504
    v_mfma_f32_16x16x32_bf16 v[72:75], v[168:171], a[48:51], 0
    ds_read_b64_tr_b16 v[192:193], v17 offset:6144
    v_mfma_f32_16x16x32_bf16 v[96:99], v[168:171], a[56:59], 0
    buffer_load_dwordx4 v3, s[32:35], s53 offen sc1 lds
    s_add_u32 m0, s56, 22528
    s_add_u32 s53, s82, 22528
    v_mfma_f32_16x16x32_bf16 v[120:123], v[168:171], a[64:67], 0
    ds_read_b64_tr_b16 v[194:195], v17 offset:6912
    v_mfma_f32_16x16x32_bf16 v[144:147], v[168:171], a[72:75], 0
    buffer_load_dwordx4 v3, s[32:35], s53 offen sc1 lds
    s_add_u32 m0, s56, 23552
    s_add_u32 s53, s82, 23552
    v_mfma_f32_16x16x32_bf16 v[76:79], v[172:175], a[48:51], 0
    ds_read_b64_tr_b16 v[196:197], v16 offset:6208
    v_mfma_f32_16x16x32_bf16 v[100:103], v[172:175], a[56:59], 0
    buffer_load_dwordx4 v3, s[32:35], s53 offen sc1 lds
    s_add_u32 m0, s56, 0
    s_add_u32 s53, s82, 24576
    v_mfma_f32_16x16x32_bf16 v[124:127], v[172:175], a[64:67], 0
    ds_read_b64_tr_b16 v[198:199], v16 offset:6976
    v_mfma_f32_16x16x32_bf16 v[148:151], v[172:175], a[72:75], 0
    buffer_load_dwordx4 v3, s[32:35], s53 offen sc1 lds
    s_add_u32 m0, s56, 1024
    s_add_u32 s53, s82, 25600
    buffer_load_dwordx4 v3, s[32:35], s53 offen sc1 lds
    s_add_u32 m0, s56, 2048
    s_add_u32 s53, s82, 26624
    v_mfma_f32_16x16x32_bf16 v[80:83], v[176:179], a[48:51], 0
    ds_read_b64_tr_b16 v[200:201], v17 offset:6208
    v_mfma_f32_16x16x32_bf16 v[104:107], v[176:179], a[56:59], 0
    buffer_load_dwordx4 v3, s[32:35], s53 offen sc1 lds
    s_add_u32 m0, s56, 3072
    s_add_u32 s53, s82, 27648
    v_mfma_f32_16x16x32_bf16 v[128:131], v[176:179], a[64:67], 0
    ds_read_b64_tr_b16 v[202:203], v17 offset:6976
    v_mfma_f32_16x16x32_bf16 v[152:155], v[176:179], a[72:75], 0
    buffer_load_dwordx4 v3, s[32:35], s53 offen sc1 lds
    s_add_u32 m0, s56, 4096
    s_add_u32 s53, s82, 28672
    v_mfma_f32_16x16x32_bf16 v[84:87], v[180:183], a[48:51], 0
    ds_read_b64_tr_b16 v[204:205], v16 offset:6272
    v_mfma_f32_16x16x32_bf16 v[108:111], v[180:183], a[56:59], 0
    buffer_load_dwordx4 v3, s[32:35], s53 offen sc1 lds
    s_add_u32 m0, s56, 5120
    s_add_u32 s53, s82, 29696
    v_mfma_f32_16x16x32_bf16 v[132:135], v[180:183], a[64:67], 0
    ds_read_b64_tr_b16 v[206:207], v16 offset:7040
    v_mfma_f32_16x16x32_bf16 v[156:159], v[180:183], a[72:75], 0
    buffer_load_dwordx4 v3, s[32:35], s53 offen sc1 lds
    s_add_u32 m0, s67, 3072
    s_add_u32 s65, s68, 768
    buffer_load_dwordx4 v27, s[20:23], s65 offen lds
    s_add_u32 m0, s67, 4096
    s_add_u32 s65, s68, 768
    v_mfma_f32_16x16x32_bf16 v[88:91], v[184:187], a[48:51], 0
    ds_read_b64_tr_b16 v[208:209], v17 offset:6272
    v_mfma_f32_16x16x32_bf16 v[112:115], v[184:187], a[56:59], 0
    s_waitcnt vmcnt(38)
    ds_read_b128 a[216:219], v8 offset:8192
    ds_read_b128 a[220:223], v9 offset:8192
    s_waitcnt lgkmcnt(15)
    buffer_load_dwordx4 v28, s[20:23], s65 offen lds
    s_add_u32 m0, s67, 5120
    s_add_u32 s65, s68, 768
    v_mfma_f32_16x16x32_bf16 v[136:139], v[184:187], a[64:67], 0
    ds_read_b64_tr_b16 v[210:211], v17 offset:7040
    v_mfma_f32_16x16x32_bf16 v[160:163], v[184:187], a[72:75], 0
    buffer_load_dwordx4 v29, s[20:23], s65 offen lds
    s_add_u32 m0, s56, 6144
    s_add_u32 s53, s82, 30720
    s_waitcnt vmcnt(15) lgkmcnt(0)
    v_mfma_f32_16x16x32_bf16 v[68:71], v[188:191], a[52:55], v[68:71]
    ds_read_b64_tr_b16 v[164:165], v16 offset:12288
    v_mfma_f32_16x16x32_bf16 v[92:95], v[188:191], a[60:63], v[92:95]
    buffer_load_dwordx4 v3, s[32:35], s53 offen sc1 lds
    s_add_u32 m0, s56, 7168
    s_add_u32 s53, s82, 31744
    v_mfma_f32_16x16x32_bf16 v[116:119], v[188:191], a[68:71], v[116:119]
    ds_read_b64_tr_b16 v[166:167], v16 offset:13056
    v_mfma_f32_16x16x32_bf16 v[140:143], v[188:191], a[76:79], v[140:143]
    v_mfma_f32_16x16x32_bf16 v[72:75], v[192:195], a[52:55], v[72:75]
    ds_read_b64_tr_b16 v[168:169], v17 offset:12288
    v_mfma_f32_16x16x32_bf16 v[96:99], v[192:195], a[60:63], v[96:99]
    buffer_load_dwordx4 v3, s[32:35], s53 offen sc1 lds
    s_add_u32 m0, s56, 8192
    s_add_u32 s53, s82, 32768
    v_mfma_f32_16x16x32_bf16 v[120:123], v[192:195], a[68:71], v[120:123]
    ds_read_b64_tr_b16 v[170:171], v17 offset:13056
    v_mfma_f32_16x16x32_bf16 v[144:147], v[192:195], a[76:79], v[144:147]
    buffer_load_dwordx4 v3, s[32:35], s53 offen sc1 lds
    s_add_u32 m0, s56, 9216
    s_add_u32 s53, s82, 33792
    v_mfma_f32_16x16x32_bf16 v[76:79], v[196:199], a[52:55], v[76:79]
    ds_read_b64_tr_b16 v[172:173], v16 offset:12352
    v_mfma_f32_16x16x32_bf16 v[100:103], v[196:199], a[60:63], v[100:103]
    buffer_load_dwordx4 v3, s[32:35], s53 offen sc1 lds
    s_add_u32 m0, s56, 10240
    s_add_u32 s53, s82, 34816
    v_mfma_f32_16x16x32_bf16 v[124:127], v[196:199], a[68:71], v[124:127]
    ds_read_b64_tr_b16 v[174:175], v16 offset:13120
    v_mfma_f32_16x16x32_bf16 v[148:151], v[196:199], a[76:79], v[148:151]
    v_mfma_f32_16x16x32_bf16 v[80:83], v[200:203], a[52:55], v[80:83]
    ds_read_b64_tr_b16 v[176:177], v17 offset:12352
    v_mfma_f32_16x16x32_bf16 v[104:107], v[200:203], a[60:63], v[104:107]
    buffer_load_dwordx4 v3, s[32:35], s53 offen sc1 lds
    s_add_u32 m0, s56, 11264
    s_add_u32 s53, s82, 35840
    v_mfma_f32_16x16x32_bf16 v[128:131], v[200:203], a[68:71], v[128:131]
    ds_read_b64_tr_b16 v[178:179], v17 offset:13120
    v_mfma_f32_16x16x32_bf16 v[152:155], v[200:203], a[76:79], v[152:155]
    buffer_load_dwordx4 v3, s[32:35], s53 offen sc1 lds
    s_add_u32 m0, s67, 6144
    s_add_u32 s65, s68, 768
    v_mfma_f32_16x16x32_bf16 v[84:87], v[204:207], a[52:55], v[84:87]
    ds_read_b64_tr_b16 v[180:181], v16 offset:12416
    v_mfma_f32_16x16x32_bf16 v[108:111], v[204:207], a[60:63], v[108:111]
    s_waitcnt vmcnt(44)
    ds_read_b128 a[224:227], v8 offset:10240
    ds_read_b128 a[228:231], v9 offset:10240
    s_waitcnt lgkmcnt(15)
    buffer_load_dwordx4 v30, s[20:23], s65 offen lds
    s_add_u32 m0, s67, 7168
    s_add_u32 s65, s68, 768
    v_mfma_f32_16x16x32_bf16 v[132:135], v[204:207], a[68:71], v[132:135]
    ds_read_b64_tr_b16 v[182:183], v16 offset:13184
    v_mfma_f32_16x16x32_bf16 v[156:159], v[204:207], a[76:79], v[156:159]
    v_mfma_f32_16x16x32_bf16 v[88:91], v[208:211], a[52:55], v[88:91]
    ds_read_b64_tr_b16 v[184:185], v17 offset:12416
    v_mfma_f32_16x16x32_bf16 v[112:115], v[208:211], a[60:63], v[112:115]
    buffer_load_dwordx4 v31, s[20:23], s65 offen lds
    s_add_u32 m0, s67, 8192
    s_add_u32 s65, s68, 896
    v_mfma_f32_16x16x32_bf16 v[136:139], v[208:211], a[68:71], v[136:139]
    ds_read_b64_tr_b16 v[186:187], v17 offset:13184
    v_mfma_f32_16x16x32_bf16 v[160:163], v[208:211], a[76:79], v[160:163]
    s_waitcnt vmcnt(44)
    ds_read_b128 a[232:235], v8 offset:12288
    ds_read_b128 a[236:239], v9 offset:12288
    s_waitcnt lgkmcnt(15)
    buffer_load_dwordx4 v24, s[20:23], s65 offen lds
    s_add_u32 m0, s56, 12288
    s_add_u32 s53, s82, 36864
    s_waitcnt vmcnt(18) lgkmcnt(0)
    v_mfma_f32_16x16x32_bf16 v[68:71], v[164:167], a[80:83], v[68:71]
    ds_read_b64_tr_b16 v[188:189], v16 offset:18432
    v_mfma_f32_16x16x32_bf16 v[92:95], v[164:167], a[88:91], v[92:95]
    buffer_load_dwordx4 v3, s[32:35], s53 offen sc1 lds
    s_add_u32 m0, s56, 13312
    s_add_u32 s53, s82, 37888
    v_mfma_f32_16x16x32_bf16 v[116:119], v[164:167], a[96:99], v[116:119]
    ds_read_b64_tr_b16 v[190:191], v16 offset:19200
    v_mfma_f32_16x16x32_bf16 v[140:143], v[164:167], a[104:107], v[140:143]
    v_mfma_f32_16x16x32_bf16 v[72:75], v[168:171], a[80:83], v[72:75]
    ds_read_b64_tr_b16 v[192:193], v17 offset:18432
    v_mfma_f32_16x16x32_bf16 v[96:99], v[168:171], a[88:91], v[96:99]
    buffer_load_dwordx4 v3, s[32:35], s53 offen sc1 lds
    s_add_u32 m0, s56, 14336
    s_add_u32 s53, s82, 38912
    v_mfma_f32_16x16x32_bf16 v[120:123], v[168:171], a[96:99], v[120:123]
    ds_read_b64_tr_b16 v[194:195], v17 offset:19200
    v_mfma_f32_16x16x32_bf16 v[144:147], v[168:171], a[104:107], v[144:147]
    buffer_load_dwordx4 v3, s[32:35], s53 offen sc1 lds
    s_add_u32 m0, s56, 15360
    s_add_u32 s53, s82, 39936
    v_mfma_f32_16x16x32_bf16 v[76:79], v[172:175], a[80:83], v[76:79]
    ds_read_b64_tr_b16 v[196:197], v16 offset:18496
    v_mfma_f32_16x16x32_bf16 v[100:103], v[172:175], a[88:91], v[100:103]
    buffer_load_dwordx4 v3, s[32:35], s53 offen sc1 lds
    s_add_u32 m0, s56, 16384
    s_add_u32 s53, s82, 40960
    v_mfma_f32_16x16x32_bf16 v[124:127], v[172:175], a[96:99], v[124:127]
    ds_read_b64_tr_b16 v[198:199], v16 offset:19264
    v_mfma_f32_16x16x32_bf16 v[148:151], v[172:175], a[104:107], v[148:151]
    v_mfma_f32_16x16x32_bf16 v[80:83], v[176:179], a[80:83], v[80:83]
    ds_read_b64_tr_b16 v[200:201], v17 offset:18496
    v_mfma_f32_16x16x32_bf16 v[104:107], v[176:179], a[88:91], v[104:107]
    buffer_load_dwordx4 v3, s[32:35], s53 offen sc1 lds
    s_add_u32 m0, s56, 17408
    s_add_u32 s53, s82, 41984
    v_mfma_f32_16x16x32_bf16 v[128:131], v[176:179], a[96:99], v[128:131]
    ds_read_b64_tr_b16 v[202:203], v17 offset:19264
    v_mfma_f32_16x16x32_bf16 v[152:155], v[176:179], a[104:107], v[152:155]
    buffer_load_dwordx4 v3, s[32:35], s53 offen sc1 lds
    s_add_u32 m0, s67, 9216
    s_add_u32 s65, s68, 896
    v_mfma_f32_16x16x32_bf16 v[84:87], v[180:183], a[80:83], v[84:87]
    ds_read_b64_tr_b16 v[204:205], v16 offset:18560
    v_mfma_f32_16x16x32_bf16 v[108:111], v[180:183], a[88:91], v[108:111]
    buffer_load_dwordx4 v25, s[20:23], s65 offen lds
    v_mfma_f32_16x16x32_bf16 v[132:135], v[180:183], a[96:99], v[132:135]
    ds_read_b64_tr_b16 v[206:207], v16 offset:19328
    s_add_u32 m0, s67, 10240
    s_add_u32 s65, s68, 896
    v_mfma_f32_16x16x32_bf16 v[156:159], v[180:183], a[104:107], v[156:159]
    v_mfma_f32_16x16x32_bf16 v[88:91], v[184:187], a[80:83], v[88:91]
    ds_read_b64_tr_b16 v[208:209], v17 offset:18560
    v_mfma_f32_16x16x32_bf16 v[112:115], v[184:187], a[88:91], v[112:115]
    s_waitcnt vmcnt(50)
    ds_read_b128 a[240:243], v8 offset:0
    ds_read_b128 a[244:247], v9 offset:0
    s_waitcnt lgkmcnt(15)
    buffer_load_dwordx4 v26, s[20:23], s65 offen lds
    s_add_u32 m0, s67, 11264
    s_add_u32 s65, s68, 896
    v_mfma_f32_16x16x32_bf16 v[136:139], v[184:187], a[96:99], v[136:139]
    ds_read_b64_tr_b16 v[210:211], v17 offset:19328
    v_mfma_f32_16x16x32_bf16 v[160:163], v[184:187], a[104:107], v[160:163]
    buffer_load_dwordx4 v27, s[20:23], s65 offen lds
    s_add_u32 m0, s56, 18432
    s_add_u32 s53, s82, 43008
    s_waitcnt vmcnt(21) lgkmcnt(0)
    v_mfma_f32_16x16x32_bf16 v[68:71], v[188:191], a[84:87], v[68:71]
    ds_read_b64_tr_b16 v[164:165], v16 offset:0
    v_mfma_f32_16x16x32_bf16 v[92:95], v[188:191], a[92:95], v[92:95]
    buffer_load_dwordx4 v3, s[32:35], s53 offen sc1 lds
    s_add_u32 m0, s56, 19456
    s_add_u32 s53, s82, 44032
    v_mfma_f32_16x16x32_bf16 v[116:119], v[188:191], a[100:103], v[116:119]
    ds_read_b64_tr_b16 v[166:167], v16 offset:768
    v_mfma_f32_16x16x32_bf16 v[140:143], v[188:191], a[108:111], v[140:143]
    v_mfma_f32_16x16x32_bf16 v[72:75], v[192:195], a[84:87], v[72:75]
    ds_read_b64_tr_b16 v[168:169], v17 offset:0
    v_mfma_f32_16x16x32_bf16 v[96:99], v[192:195], a[92:95], v[96:99]
    buffer_load_dwordx4 v3, s[32:35], s53 offen sc1 lds
    s_add_u32 m0, s56, 20480
    s_add_u32 s53, s82, 45056
    v_mfma_f32_16x16x32_bf16 v[120:123], v[192:195], a[100:103], v[120:123]
    ds_read_b64_tr_b16 v[170:171], v17 offset:768
    v_mfma_f32_16x16x32_bf16 v[144:147], v[192:195], a[108:111], v[144:147]
    buffer_load_dwordx4 v3, s[32:35], s53 offen sc1 lds
    s_add_u32 m0, s56, 21504
    s_add_u32 s53, s82, 46080
    v_mfma_f32_16x16x32_bf16 v[76:79], v[196:199], a[84:87], v[76:79]
    ds_read_b64_tr_b16 v[172:173], v16 offset:64
    v_mfma_f32_16x16x32_bf16 v[100:103], v[196:199], a[92:95], v[100:103]
    buffer_load_dwordx4 v3, s[32:35], s53 offen sc1 lds
    s_add_u32 m0, s56, 22528
    s_add_u32 s53, s82, 47104
    v_mfma_f32_16x16x32_bf16 v[124:127], v[196:199], a[100:103], v[124:127]
    ds_read_b64_tr_b16 v[174:175], v16 offset:832
    v_mfma_f32_16x16x32_bf16 v[148:151], v[196:199], a[108:111], v[148:151]
    v_mfma_f32_16x16x32_bf16 v[80:83], v[200:203], a[84:87], v[80:83]
    ds_read_b64_tr_b16 v[176:177], v17 offset:64
    v_mfma_f32_16x16x32_bf16 v[104:107], v[200:203], a[92:95], v[104:107]
    buffer_load_dwordx4 v3, s[32:35], s53 offen sc1 lds
    s_add_u32 m0, s56, 23552
    s_add_u32 s53, s82, 48128
    v_mfma_f32_16x16x32_bf16 v[128:131], v[200:203], a[100:103], v[128:131]
    ds_read_b64_tr_b16 v[178:179], v17 offset:832
    v_mfma_f32_16x16x32_bf16 v[152:155], v[200:203], a[108:111], v[152:155]
    buffer_load_dwordx4 v3, s[32:35], s53 offen sc1 lds
    s_add_u32 m0, s67, 12288
    s_add_u32 s65, s68, 896
    v_mfma_f32_16x16x32_bf16 v[84:87], v[204:207], a[84:87], v[84:87]
    ds_read_b64_tr_b16 v[180:181], v16 offset:128
    v_mfma_f32_16x16x32_bf16 v[108:111], v[204:207], a[92:95], v[108:111]
    s_waitcnt vmcnt(26)
    ds_read_b128 a[248:251], v8 offset:2048
    ds_read_b128 a[252:255], v9 offset:2048
    s_waitcnt lgkmcnt(15)
    buffer_load_dwordx4 v28, s[20:23], s65 offen lds
    s_add_u32 m0, s67, 13312
    s_add_u32 s65, s68, 896
    v_mfma_f32_16x16x32_bf16 v[132:135], v[204:207], a[100:103], v[132:135]
    ds_read_b64_tr_b16 v[182:183], v16 offset:896
    v_mfma_f32_16x16x32_bf16 v[156:159], v[204:207], a[108:111], v[156:159]
    v_mfma_f32_16x16x32_bf16 v[88:91], v[208:211], a[84:87], v[88:91]
    ds_read_b64_tr_b16 v[184:185], v17 offset:128
    v_mfma_f32_16x16x32_bf16 v[112:115], v[208:211], a[92:95], v[112:115]
    buffer_load_dwordx4 v29, s[20:23], s65 offen lds
    s_add_u32 m0, s67, 0
    s_add_u32 s65, s68, 896
    v_mfma_f32_16x16x32_bf16 v[136:139], v[208:211], a[100:103], v[136:139]
    ds_read_b64_tr_b16 v[186:187], v17 offset:896
    v_mfma_f32_16x16x32_bf16 v[160:163], v[208:211], a[108:111], v[160:163]
    s_waitcnt vmcnt(26)
    ds_read_b128 a[0:3], v8 offset:4096
    ds_read_b128 a[4:7], v9 offset:4096
    s_waitcnt lgkmcnt(15)
    buffer_load_dwordx4 v30, s[20:23], s65 offen lds
    s_add_u32 m0, s56, 0
    s_add_u32 s53, s82, 49152
    s_waitcnt vmcnt(21) lgkmcnt(0)
    v_mfma_f32_16x16x32_bf16 v[68:71], v[164:167], a[112:115], v[68:71]
    ds_read_b64_tr_b16 v[188:189], v16 offset:6144
    v_mfma_f32_16x16x32_bf16 v[92:95], v[164:167], a[120:123], v[92:95]
    v_mfma_f32_16x16x32_bf16 v[116:119], v[164:167], a[128:131], v[116:119]
    ds_read_b64_tr_b16 v[190:191], v16 offset:6912
    v_mfma_f32_16x16x32_bf16 v[140:143], v[164:167], a[136:139], v[140:143]
    buffer_load_dwordx4 v3, s[32:35], s53 offen sc1 lds
    s_add_u32 m0, s56, 1024
    s_add_u32 s53, s82, 50176
    v_mfma_f32_16x16x32_bf16 v[72:75], v[168:171], a[112:115], v[72:75]
    ds_read_b64_tr_b16 v[192:193], v17 offset:6144
    v_mfma_f32_16x16x32_bf16 v[96:99], v[168:171], a[120:123], v[96:99]
    buffer_load_dwordx4 v3, s[32:35], s53 offen sc1 lds
    s_add_u32 m0, s56, 2048
    s_add_u32 s53, s82, 51200
    v_mfma_f32_16x16x32_bf16 v[120:123], v[168:171], a[128:131], v[120:123]
    ds_read_b64_tr_b16 v[194:195], v17 offset:6912
    v_mfma_f32_16x16x32_bf16 v[144:147], v[168:171], a[136:139], v[144:147]
    v_mfma_f32_16x16x32_bf16 v[76:79], v[172:175], a[112:115], v[76:79]
    ds_read_b64_tr_b16 v[196:197], v16 offset:6208
    v_mfma_f32_16x16x32_bf16 v[100:103], v[172:175], a[120:123], v[100:103]
    buffer_load_dwordx4 v3, s[32:35], s53 offen sc1 lds
    s_add_u32 m0, s56, 3072
    s_add_u32 s53, s82, 52224
    v_mfma_f32_16x16x32_bf16 v[124:127], v[172:175], a[128:131], v[124:127]
    ds_read_b64_tr_b16 v[198:199], v16 offset:6976
    v_mfma_f32_16x16x32_bf16 v[148:151], v[172:175], a[136:139], v[148:151]
    v_mfma_f32_16x16x32_bf16 v[80:83], v[176:179], a[112:115], v[80:83]
    ds_read_b64_tr_b16 v[200:201], v17 offset:6208
    v_mfma_f32_16x16x32_bf16 v[104:107], v[176:179], a[120:123], v[104:107]
    buffer_load_dwordx4 v3, s[32:35], s53 offen sc1 lds
    s_add_u32 m0, s56, 4096
    s_add_u32 s53, s82, 53248
    v_mfma_f32_16x16x32_bf16 v[128:131], v[176:179], a[128:131], v[128:131]
    ds_read_b64_tr_b16 v[202:203], v17 offset:6976
    v_mfma_f32_16x16x32_bf16 v[152:155], v[176:179], a[136:139], v[152:155]
    v_mfma_f32_16x16x32_bf16 v[84:87], v[180:183], a[112:115], v[84:87]
    ds_read_b64_tr_b16 v[204:205], v16 offset:6272
    v_mfma_f32_16x16x32_bf16 v[108:111], v[180:183], a[120:123], v[108:111]
    buffer_load_dwordx4 v3, s[32:35], s53 offen sc1 lds
    s_add_u32 m0, s56, 5120
    s_add_u32 s53, s82, 54272
    v_mfma_f32_16x16x32_bf16 v[132:135], v[180:183], a[128:131], v[132:135]
    ds_read_b64_tr_b16 v[206:207], v16 offset:7040
    v_mfma_f32_16x16x32_bf16 v[156:159], v[180:183], a[136:139], v[156:159]
    buffer_load_dwordx4 v3, s[32:35], s53 offen sc1 lds
    s_add_u32 m0, s67, 1024
    s_add_u32 s65, s68, 896
    v_mfma_f32_16x16x32_bf16 v[88:91], v[184:187], a[112:115], v[88:91]
    ds_read_b64_tr_b16 v[208:209], v17 offset:6272
    v_mfma_f32_16x16x32_bf16 v[112:115], v[184:187], a[120:123], v[112:115]
    v_mfma_f32_16x16x32_bf16 v[136:139], v[184:187], a[128:131], v[136:139]
    ds_read_b64_tr_b16 v[210:211], v17 offset:7040
    v_mfma_f32_16x16x32_bf16 v[160:163], v[184:187], a[136:139], v[160:163]
    buffer_load_dwordx4 v31, s[20:23], s65 offen lds
    s_add_u32 m0, s56, 6144
    s_add_u32 s53, s82, 55296
    s_waitcnt vmcnt(19) lgkmcnt(0)
    v_mfma_f32_16x16x32_bf16 v[68:71], v[188:191], a[116:119], v[68:71]
    ds_read_b64_tr_b16 v[164:165], v16 offset:12288
    v_mfma_f32_16x16x32_bf16 v[92:95], v[188:191], a[124:127], v[92:95]
    v_mfma_f32_16x16x32_bf16 v[116:119], v[188:191], a[132:135], v[116:119]
    ds_read_b64_tr_b16 v[166:167], v16 offset:13056
    v_mfma_f32_16x16x32_bf16 v[140:143], v[188:191], a[140:143], v[140:143]
    buffer_load_dwordx4 v3, s[32:35], s53 offen sc1 lds
    v_mfma_f32_16x16x32_bf16 v[72:75], v[192:195], a[116:119], v[72:75]
    ds_read_b64_tr_b16 v[168:169], v17 offset:12288
    v_mfma_f32_16x16x32_bf16 v[96:99], v[192:195], a[124:127], v[96:99]
    buffer_load_dwordx4 v3, s[32:35], s53 offen offset:1024 sc1 lds
    v_mfma_f32_16x16x32_bf16 v[120:123], v[192:195], a[132:135], v[120:123]
    ds_read_b64_tr_b16 v[170:171], v17 offset:13056
    v_mfma_f32_16x16x32_bf16 v[144:147], v[192:195], a[140:143], v[144:147]
    v_mfma_f32_16x16x32_bf16 v[76:79], v[196:199], a[116:119], v[76:79]
    ds_read_b64_tr_b16 v[172:173], v16 offset:12352
    v_mfma_f32_16x16x32_bf16 v[100:103], v[196:199], a[124:127], v[100:103]
    buffer_load_dwordx4 v3, s[32:35], s53 offen offset:2048 sc1 lds
    v_mfma_f32_16x16x32_bf16 v[124:127], v[196:199], a[132:135], v[124:127]
    ds_read_b64_tr_b16 v[174:175], v16 offset:13120
    v_mfma_f32_16x16x32_bf16 v[148:151], v[196:199], a[140:143], v[148:151]
    v_mfma_f32_16x16x32_bf16 v[80:83], v[200:203], a[116:119], v[80:83]
    ds_read_b64_tr_b16 v[176:177], v17 offset:12352
    v_mfma_f32_16x16x32_bf16 v[104:107], v[200:203], a[124:127], v[104:107]
    buffer_load_dwordx4 v3, s[32:35], s53 offen offset:3072 sc1 lds
    s_add_u32 m0, m0, 4096
    s_add_u32 s53, s53, 4096
    v_mfma_f32_16x16x32_bf16 v[128:131], v[200:203], a[132:135], v[128:131]
    ds_read_b64_tr_b16 v[178:179], v17 offset:13120
    v_mfma_f32_16x16x32_bf16 v[152:155], v[200:203], a[140:143], v[152:155]
    v_mfma_f32_16x16x32_bf16 v[84:87], v[204:207], a[116:119], v[84:87]
    ds_read_b64_tr_b16 v[180:181], v16 offset:12416
    v_mfma_f32_16x16x32_bf16 v[108:111], v[204:207], a[124:127], v[108:111]
    buffer_load_dwordx4 v3, s[32:35], s53 offen sc1 lds
    v_mfma_f32_16x16x32_bf16 v[132:135], v[204:207], a[132:135], v[132:135]
    ds_read_b64_tr_b16 v[182:183], v16 offset:13184
    v_mfma_f32_16x16x32_bf16 v[156:159], v[204:207], a[140:143], v[156:159]
    buffer_load_dwordx4 v3, s[32:35], s53 offen offset:1024 sc1 lds
    v_mfma_f32_16x16x32_bf16 v[88:91], v[208:211], a[116:119], v[88:91]
    ds_read_b64_tr_b16 v[184:185], v17 offset:12416
    v_mfma_f32_16x16x32_bf16 v[112:115], v[208:211], a[124:127], v[112:115]
    v_mfma_f32_16x16x32_bf16 v[136:139], v[208:211], a[132:135], v[136:139]
    ds_read_b64_tr_b16 v[186:187], v17 offset:13184
    v_mfma_f32_16x16x32_bf16 v[160:163], v[208:211], a[140:143], v[160:163]
    s_waitcnt vmcnt(32)
    ds_read_b128 a[8:11], v8 offset:6144
    ds_read_b128 a[12:15], v9 offset:6144
    s_waitcnt vmcnt(24)
    ds_read_b128 a[16:19], v8 offset:8192
    ds_read_b128 a[20:23], v9 offset:8192
    s_waitcnt vmcnt(22)
    ds_read_b128 a[24:27], v8 offset:10240
    ds_read_b128 a[28:31], v9 offset:10240
    s_waitcnt vmcnt(14)
    ds_read_b128 a[32:35], v8 offset:12288
    ds_read_b128 a[36:39], v9 offset:12288
    s_waitcnt vmcnt(6)
    ds_read_b128 a[40:43], v8 offset:0
    s_add_u32 m0, s56, 12288
    s_add_u32 s53, s82, 61440
    ds_read_b128 a[44:47], v9 offset:0
    s_waitcnt vmcnt(16) lgkmcnt(0)
    v_mfma_f32_16x16x32_bf16 v[68:71], v[164:167], a[144:147], v[68:71]
    ds_read_b64_tr_b16 v[188:189], v16 offset:18432
    v_mfma_f32_16x16x32_bf16 v[92:95], v[164:167], a[152:155], v[92:95]
    v_mfma_f32_16x16x32_bf16 v[116:119], v[164:167], a[160:163], v[116:119]
    ds_read_b64_tr_b16 v[190:191], v16 offset:19200
    v_mfma_f32_16x16x32_bf16 v[140:143], v[164:167], a[168:171], v[140:143]
    buffer_load_dwordx4 v3, s[32:35], s53 offen sc1 lds
    v_mfma_f32_16x16x32_bf16 v[72:75], v[168:171], a[144:147], v[72:75]
    ds_read_b64_tr_b16 v[192:193], v17 offset:18432
    v_mfma_f32_16x16x32_bf16 v[96:99], v[168:171], a[152:155], v[96:99]
    v_mfma_f32_16x16x32_bf16 v[120:123], v[168:171], a[160:163], v[120:123]
    ds_read_b64_tr_b16 v[194:195], v17 offset:19200
    v_mfma_f32_16x16x32_bf16 v[144:147], v[168:171], a[168:171], v[144:147]
    buffer_load_dwordx4 v3, s[32:35], s53 offen offset:1024 sc1 lds
    v_mfma_f32_16x16x32_bf16 v[76:79], v[172:175], a[144:147], v[76:79]
    ds_read_b64_tr_b16 v[196:197], v16 offset:18496
    v_mfma_f32_16x16x32_bf16 v[100:103], v[172:175], a[152:155], v[100:103]
    v_mfma_f32_16x16x32_bf16 v[124:127], v[172:175], a[160:163], v[124:127]
    ds_read_b64_tr_b16 v[198:199], v16 offset:19264
    v_mfma_f32_16x16x32_bf16 v[148:151], v[172:175], a[168:171], v[148:151]
    buffer_load_dwordx4 v3, s[32:35], s53 offen offset:2048 sc1 lds
    v_mfma_f32_16x16x32_bf16 v[80:83], v[176:179], a[144:147], v[80:83]
    ds_read_b64_tr_b16 v[200:201], v17 offset:18496
    v_mfma_f32_16x16x32_bf16 v[104:107], v[176:179], a[152:155], v[104:107]
    v_mfma_f32_16x16x32_bf16 v[128:131], v[176:179], a[160:163], v[128:131]
    ds_read_b64_tr_b16 v[202:203], v17 offset:19264
    v_mfma_f32_16x16x32_bf16 v[152:155], v[176:179], a[168:171], v[152:155]
    buffer_load_dwordx4 v3, s[32:35], s53 offen offset:3072 sc1 lds
    s_add_u32 m0, m0, 4096
    s_add_u32 s53, s53, 4096
    v_mfma_f32_16x16x32_bf16 v[84:87], v[180:183], a[144:147], v[84:87]
    ds_read_b64_tr_b16 v[204:205], v16 offset:18560
    v_mfma_f32_16x16x32_bf16 v[108:111], v[180:183], a[152:155], v[108:111]
    v_mfma_f32_16x16x32_bf16 v[132:135], v[180:183], a[160:163], v[132:135]
    ds_read_b64_tr_b16 v[206:207], v16 offset:19328
    v_mfma_f32_16x16x32_bf16 v[156:159], v[180:183], a[168:171], v[156:159]
    buffer_load_dwordx4 v3, s[32:35], s53 offen sc1 lds
    v_mfma_f32_16x16x32_bf16 v[88:91], v[184:187], a[144:147], v[88:91]
    ds_read_b64_tr_b16 v[208:209], v17 offset:18560
    v_mfma_f32_16x16x32_bf16 v[112:115], v[184:187], a[152:155], v[112:115]
    v_mfma_f32_16x16x32_bf16 v[136:139], v[184:187], a[160:163], v[136:139]
    ds_read_b64_tr_b16 v[210:211], v17 offset:19328
    v_mfma_f32_16x16x32_bf16 v[160:163], v[184:187], a[168:171], v[160:163]
    buffer_load_dwordx4 v3, s[32:35], s53 offen offset:1024 sc1 lds
    s_add_u32 m0, s56, 18432
    s_add_u32 s53, s82, 67584
    s_waitcnt vmcnt(13) lgkmcnt(0)
    s_barrier
    v_mfma_f32_16x16x32_bf16 v[68:71], v[188:191], a[148:151], v[68:71]
    ds_read_b64_tr_b16 v[164:165], v16 offset:0
    v_mfma_f32_16x16x32_bf16 v[92:95], v[188:191], a[156:159], v[92:95]
    v_mfma_f32_16x16x32_bf16 v[116:119], v[188:191], a[164:167], v[116:119]
    ds_read_b64_tr_b16 v[166:167], v16 offset:768
    v_mfma_f32_16x16x32_bf16 v[140:143], v[188:191], a[172:175], v[140:143]
    buffer_load_dwordx4 v3, s[32:35], s53 offen sc1 lds
    v_mfma_f32_16x16x32_bf16 v[72:75], v[192:195], a[148:151], v[72:75]
    ds_read_b64_tr_b16 v[168:169], v17 offset:0
    v_mfma_f32_16x16x32_bf16 v[96:99], v[192:195], a[156:159], v[96:99]
    v_mfma_f32_16x16x32_bf16 v[120:123], v[192:195], a[164:167], v[120:123]
    ds_read_b64_tr_b16 v[170:171], v17 offset:768
    v_mfma_f32_16x16x32_bf16 v[144:147], v[192:195], a[172:175], v[144:147]
    buffer_load_dwordx4 v3, s[32:35], s53 offen offset:1024 sc1 lds
    v_mfma_f32_16x16x32_bf16 v[76:79], v[196:199], a[148:151], v[76:79]
    ds_read_b64_tr_b16 v[172:173], v16 offset:64
    v_mfma_f32_16x16x32_bf16 v[100:103], v[196:199], a[156:159], v[100:103]
    v_mfma_f32_16x16x32_bf16 v[124:127], v[196:199], a[164:167], v[124:127]
    ds_read_b64_tr_b16 v[174:175], v16 offset:832
    v_mfma_f32_16x16x32_bf16 v[148:151], v[196:199], a[172:175], v[148:151]
    buffer_load_dwordx4 v3, s[32:35], s53 offen offset:2048 sc1 lds
    v_mfma_f32_16x16x32_bf16 v[80:83], v[200:203], a[148:151], v[80:83]
    ds_read_b64_tr_b16 v[176:177], v17 offset:64
    v_mfma_f32_16x16x32_bf16 v[104:107], v[200:203], a[156:159], v[104:107]
    v_mfma_f32_16x16x32_bf16 v[128:131], v[200:203], a[164:167], v[128:131]
    ds_read_b64_tr_b16 v[178:179], v17 offset:832
    v_mfma_f32_16x16x32_bf16 v[152:155], v[200:203], a[172:175], v[152:155]
    buffer_load_dwordx4 v3, s[32:35], s53 offen offset:3072 sc1 lds
    s_add_u32 m0, m0, 4096
    s_add_u32 s53, s53, 4096
    v_mfma_f32_16x16x32_bf16 v[84:87], v[204:207], a[148:151], v[84:87]
    ds_read_b64_tr_b16 v[180:181], v16 offset:128
    v_mfma_f32_16x16x32_bf16 v[108:111], v[204:207], a[156:159], v[108:111]
    v_mfma_f32_16x16x32_bf16 v[132:135], v[204:207], a[164:167], v[132:135]
    ds_read_b64_tr_b16 v[182:183], v16 offset:896
    v_mfma_f32_16x16x32_bf16 v[156:159], v[204:207], a[172:175], v[156:159]
    buffer_load_dwordx4 v3, s[32:35], s53 offen sc1 lds
    v_mfma_f32_16x16x32_bf16 v[88:91], v[208:211], a[148:151], v[88:91]
    ds_read_b64_tr_b16 v[184:185], v17 offset:128
    v_mfma_f32_16x16x32_bf16 v[112:115], v[208:211], a[156:159], v[112:115]
    v_mfma_f32_16x16x32_bf16 v[136:139], v[208:211], a[164:167], v[136:139]
    ds_read_b64_tr_b16 v[186:187], v17 offset:896
    v_mfma_f32_16x16x32_bf16 v[160:163], v[208:211], a[172:175], v[160:163]
    buffer_load_dwordx4 v3, s[32:35], s53 offen offset:1024 sc1 lds
    s_add_u32 m0, s56, 0
    s_add_u32 s53, s82, 73728
    s_waitcnt vmcnt(12) lgkmcnt(0)
    v_mfma_f32_16x16x32_bf16 v[68:71], v[164:167], a[176:179], v[68:71]
    ds_read_b64_tr_b16 v[188:189], v16 offset:6144
    v_mfma_f32_16x16x32_bf16 v[92:95], v[164:167], a[184:187], v[92:95]
    v_mfma_f32_16x16x32_bf16 v[116:119], v[164:167], a[192:195], v[116:119]
    ds_read_b64_tr_b16 v[190:191], v16 offset:6912
    v_mfma_f32_16x16x32_bf16 v[140:143], v[164:167], a[200:203], v[140:143]
    buffer_load_dwordx4 v3, s[32:35], s53 offen sc1 lds
    v_mfma_f32_16x16x32_bf16 v[72:75], v[168:171], a[176:179], v[72:75]
    ds_read_b64_tr_b16 v[192:193], v17 offset:6144
    v_mfma_f32_16x16x32_bf16 v[96:99], v[168:171], a[184:187], v[96:99]
    v_mfma_f32_16x16x32_bf16 v[120:123], v[168:171], a[192:195], v[120:123]
    ds_read_b64_tr_b16 v[194:195], v17 offset:6912
    v_mfma_f32_16x16x32_bf16 v[144:147], v[168:171], a[200:203], v[144:147]
    buffer_load_dwordx4 v3, s[32:35], s53 offen offset:1024 sc1 lds
    v_mfma_f32_16x16x32_bf16 v[76:79], v[172:175], a[176:179], v[76:79]
    ds_read_b64_tr_b16 v[196:197], v16 offset:6208
    v_mfma_f32_16x16x32_bf16 v[100:103], v[172:175], a[184:187], v[100:103]
    v_mfma_f32_16x16x32_bf16 v[124:127], v[172:175], a[192:195], v[124:127]
    ds_read_b64_tr_b16 v[198:199], v16 offset:6976
    v_mfma_f32_16x16x32_bf16 v[148:151], v[172:175], a[200:203], v[148:151]
    buffer_load_dwordx4 v3, s[32:35], s53 offen offset:2048 sc1 lds
    v_mfma_f32_16x16x32_bf16 v[80:83], v[176:179], a[176:179], v[80:83]
    ds_read_b64_tr_b16 v[200:201], v17 offset:6208
    v_mfma_f32_16x16x32_bf16 v[104:107], v[176:179], a[184:187], v[104:107]
    v_mfma_f32_16x16x32_bf16 v[128:131], v[176:179], a[192:195], v[128:131]
    ds_read_b64_tr_b16 v[202:203], v17 offset:6976
    v_mfma_f32_16x16x32_bf16 v[152:155], v[176:179], a[200:203], v[152:155]
    buffer_load_dwordx4 v3, s[32:35], s53 offen offset:3072 sc1 lds
    s_add_u32 m0, m0, 4096
    s_add_u32 s53, s53, 4096
    v_mfma_f32_16x16x32_bf16 v[84:87], v[180:183], a[176:179], v[84:87]
    ds_read_b64_tr_b16 v[204:205], v16 offset:6272
    v_mfma_f32_16x16x32_bf16 v[108:111], v[180:183], a[184:187], v[108:111]
    v_mfma_f32_16x16x32_bf16 v[132:135], v[180:183], a[192:195], v[132:135]
    ds_read_b64_tr_b16 v[206:207], v16 offset:7040
    v_mfma_f32_16x16x32_bf16 v[156:159], v[180:183], a[200:203], v[156:159]
    buffer_load_dwordx4 v3, s[32:35], s53 offen sc1 lds
    v_mfma_f32_16x16x32_bf16 v[88:91], v[184:187], a[176:179], v[88:91]
    ds_read_b64_tr_b16 v[208:209], v17 offset:6272
    v_mfma_f32_16x16x32_bf16 v[112:115], v[184:187], a[184:187], v[112:115]
    v_mfma_f32_16x16x32_bf16 v[136:139], v[184:187], a[192:195], v[136:139]
    ds_read_b64_tr_b16 v[210:211], v17 offset:7040
    v_mfma_f32_16x16x32_bf16 v[160:163], v[184:187], a[200:203], v[160:163]
    buffer_load_dwordx4 v3, s[32:35], s53 offen offset:1024 sc1 lds
    s_add_u32 m0, s56, 6144
    s_add_u32 s53, s82, 79872
    s_waitcnt vmcnt(12) lgkmcnt(0)
    v_mfma_f32_16x16x32_bf16 v[68:71], v[188:191], a[180:183], v[68:71]
    ds_read_b64_tr_b16 v[164:165], v16 offset:12288
    v_mfma_f32_16x16x32_bf16 v[92:95], v[188:191], a[188:191], v[92:95]
    v_mfma_f32_16x16x32_bf16 v[116:119], v[188:191], a[196:199], v[116:119]
    ds_read_b64_tr_b16 v[166:167], v16 offset:13056
    v_mfma_f32_16x16x32_bf16 v[140:143], v[188:191], a[204:207], v[140:143]
    buffer_load_dwordx4 v3, s[32:35], s53 offen sc1 lds
    v_mfma_f32_16x16x32_bf16 v[72:75], v[192:195], a[180:183], v[72:75]
    ds_read_b64_tr_b16 v[168:169], v17 offset:12288
    v_mfma_f32_16x16x32_bf16 v[96:99], v[192:195], a[188:191], v[96:99]
    v_mfma_f32_16x16x32_bf16 v[120:123], v[192:195], a[196:199], v[120:123]
    ds_read_b64_tr_b16 v[170:171], v17 offset:13056
    v_mfma_f32_16x16x32_bf16 v[144:147], v[192:195], a[204:207], v[144:147]
    buffer_load_dwordx4 v3, s[32:35], s53 offen offset:1024 sc1 lds
    v_mfma_f32_16x16x32_bf16 v[76:79], v[196:199], a[180:183], v[76:79]
    ds_read_b64_tr_b16 v[172:173], v16 offset:12352
    v_mfma_f32_16x16x32_bf16 v[100:103], v[196:199], a[188:191], v[100:103]
    v_mfma_f32_16x16x32_bf16 v[124:127], v[196:199], a[196:199], v[124:127]
    ds_read_b64_tr_b16 v[174:175], v16 offset:13120
    v_mfma_f32_16x16x32_bf16 v[148:151], v[196:199], a[204:207], v[148:151]
    buffer_load_dwordx4 v3, s[32:35], s53 offen offset:2048 sc1 lds
    v_mfma_f32_16x16x32_bf16 v[80:83], v[200:203], a[180:183], v[80:83]
    ds_read_b64_tr_b16 v[176:177], v17 offset:12352
    v_mfma_f32_16x16x32_bf16 v[104:107], v[200:203], a[188:191], v[104:107]
    v_mfma_f32_16x16x32_bf16 v[128:131], v[200:203], a[196:199], v[128:131]
    ds_read_b64_tr_b16 v[178:179], v17 offset:13120
    v_mfma_f32_16x16x32_bf16 v[152:155], v[200:203], a[204:207], v[152:155]
    buffer_load_dwordx4 v3, s[32:35], s53 offen offset:3072 sc1 lds
    s_add_u32 m0, m0, 4096
    s_add_u32 s53, s53, 4096
    v_mfma_f32_16x16x32_bf16 v[84:87], v[204:207], a[180:183], v[84:87]
    ds_read_b64_tr_b16 v[180:181], v16 offset:12416
    v_mfma_f32_16x16x32_bf16 v[108:111], v[204:207], a[188:191], v[108:111]
    v_mfma_f32_16x16x32_bf16 v[132:135], v[204:207], a[196:199], v[132:135]
    ds_read_b64_tr_b16 v[182:183], v16 offset:13184
    v_mfma_f32_16x16x32_bf16 v[156:159], v[204:207], a[204:207], v[156:159]
    buffer_load_dwordx4 v3, s[32:35], s53 offen sc1 lds
    v_mfma_f32_16x16x32_bf16 v[88:91], v[208:211], a[180:183], v[88:91]
    ds_read_b64_tr_b16 v[184:185], v17 offset:12416
    v_mfma_f32_16x16x32_bf16 v[112:115], v[208:211], a[188:191], v[112:115]
    v_mfma_f32_16x16x32_bf16 v[136:139], v[208:211], a[196:199], v[136:139]
    ds_read_b64_tr_b16 v[186:187], v17 offset:13184
    v_mfma_f32_16x16x32_bf16 v[160:163], v[208:211], a[204:207], v[160:163]
    buffer_load_dwordx4 v3, s[32:35], s53 offen offset:1024 sc1 lds
    s_add_u32 m0, s56, 12288
    s_add_u32 s53, s82, 86016
    s_waitcnt vmcnt(12) lgkmcnt(0)
    v_mfma_f32_16x16x32_bf16 v[68:71], v[164:167], a[208:211], v[68:71]
    ds_read_b64_tr_b16 v[188:189], v16 offset:18432
    v_mfma_f32_16x16x32_bf16 v[92:95], v[164:167], a[216:219], v[92:95]
    v_mfma_f32_16x16x32_bf16 v[116:119], v[164:167], a[224:227], v[116:119]
    ds_read_b64_tr_b16 v[190:191], v16 offset:19200
    v_mfma_f32_16x16x32_bf16 v[140:143], v[164:167], a[232:235], v[140:143]
    buffer_load_dwordx4 v3, s[32:35], s53 offen sc1 lds
    v_mfma_f32_16x16x32_bf16 v[72:75], v[168:171], a[208:211], v[72:75]
    ds_read_b64_tr_b16 v[192:193], v17 offset:18432
    v_mfma_f32_16x16x32_bf16 v[96:99], v[168:171], a[216:219], v[96:99]
    v_mfma_f32_16x16x32_bf16 v[120:123], v[168:171], a[224:227], v[120:123]
    ds_read_b64_tr_b16 v[194:195], v17 offset:19200
    v_mfma_f32_16x16x32_bf16 v[144:147], v[168:171], a[232:235], v[144:147]
    buffer_load_dwordx4 v3, s[32:35], s53 offen offset:1024 sc1 lds
    v_mfma_f32_16x16x32_bf16 v[76:79], v[172:175], a[208:211], v[76:79]
    ds_read_b64_tr_b16 v[196:197], v16 offset:18496
    v_mfma_f32_16x16x32_bf16 v[100:103], v[172:175], a[216:219], v[100:103]
    v_mfma_f32_16x16x32_bf16 v[124:127], v[172:175], a[224:227], v[124:127]
    ds_read_b64_tr_b16 v[198:199], v16 offset:19264
    v_mfma_f32_16x16x32_bf16 v[148:151], v[172:175], a[232:235], v[148:151]
    buffer_load_dwordx4 v3, s[32:35], s53 offen offset:2048 sc1 lds
    v_mfma_f32_16x16x32_bf16 v[80:83], v[176:179], a[208:211], v[80:83]
    ds_read_b64_tr_b16 v[200:201], v17 offset:18496
    v_mfma_f32_16x16x32_bf16 v[104:107], v[176:179], a[216:219], v[104:107]
    v_mfma_f32_16x16x32_bf16 v[128:131], v[176:179], a[224:227], v[128:131]
    ds_read_b64_tr_b16 v[202:203], v17 offset:19264
    v_mfma_f32_16x16x32_bf16 v[152:155], v[176:179], a[232:235], v[152:155]
    buffer_load_dwordx4 v3, s[32:35], s53 offen offset:3072 sc1 lds
    s_add_u32 m0, m0, 4096
    s_add_u32 s53, s53, 4096
    v_mfma_f32_16x16x32_bf16 v[84:87], v[180:183], a[208:211], v[84:87]
    ds_read_b64_tr_b16 v[204:205], v16 offset:18560
    v_mfma_f32_16x16x32_bf16 v[108:111], v[180:183], a[216:219], v[108:111]
    v_mfma_f32_16x16x32_bf16 v[132:135], v[180:183], a[224:227], v[132:135]
    ds_read_b64_tr_b16 v[206:207], v16 offset:19328
    v_mfma_f32_16x16x32_bf16 v[156:159], v[180:183], a[232:235], v[156:159]
    buffer_load_dwordx4 v3, s[32:35], s53 offen sc1 lds
    v_mfma_f32_16x16x32_bf16 v[88:91], v[184:187], a[208:211], v[88:91]
    ds_read_b64_tr_b16 v[208:209], v17 offset:18560
    v_mfma_f32_16x16x32_bf16 v[112:115], v[184:187], a[216:219], v[112:115]
    v_mfma_f32_16x16x32_bf16 v[136:139], v[184:187], a[224:227], v[136:139]
    ds_read_b64_tr_b16 v[210:211], v17 offset:19328
    v_mfma_f32_16x16x32_bf16 v[160:163], v[184:187], a[232:235], v[160:163]
    buffer_load_dwordx4 v3, s[32:35], s53 offen offset:1024 sc1 lds
    s_add_u32 m0, s56, 18432
    s_add_u32 s53, s82, 92160
    s_waitcnt vmcnt(12) lgkmcnt(0)
    v_mfma_f32_16x16x32_bf16 v[68:71], v[188:191], a[212:215], v[68:71]
    ds_read_b64_tr_b16 v[164:165], v16 offset:0
    v_mfma_f32_16x16x32_bf16 v[92:95], v[188:191], a[220:223], v[92:95]
    v_mfma_f32_16x16x32_bf16 v[116:119], v[188:191], a[228:231], v[116:119]
    ds_read_b64_tr_b16 v[166:167], v16 offset:768
    v_mfma_f32_16x16x32_bf16 v[140:143], v[188:191], a[236:239], v[140:143]
    buffer_load_dwordx4 v3, s[32:35], s53 offen sc1 lds
    v_mfma_f32_16x16x32_bf16 v[72:75], v[192:195], a[212:215], v[72:75]
    ds_read_b64_tr_b16 v[168:169], v17 offset:0
    v_mfma_f32_16x16x32_bf16 v[96:99], v[192:195], a[220:223], v[96:99]
    v_mfma_f32_16x16x32_bf16 v[120:123], v[192:195], a[228:231], v[120:123]
    ds_read_b64_tr_b16 v[170:171], v17 offset:768
    v_mfma_f32_16x16x32_bf16 v[144:147], v[192:195], a[236:239], v[144:147]
    buffer_load_dwordx4 v3, s[32:35], s53 offen offset:1024 sc1 lds
    v_mfma_f32_16x16x32_bf16 v[76:79], v[196:199], a[212:215], v[76:79]
    ds_read_b64_tr_b16 v[172:173], v16 offset:64
    v_mfma_f32_16x16x32_bf16 v[100:103], v[196:199], a[220:223], v[100:103]
    v_mfma_f32_16x16x32_bf16 v[124:127], v[196:199], a[228:231], v[124:127]
    ds_read_b64_tr_b16 v[174:175], v16 offset:832
    v_mfma_f32_16x16x32_bf16 v[148:151], v[196:199], a[236:239], v[148:151]
    buffer_load_dwordx4 v3, s[32:35], s53 offen offset:2048 sc1 lds
    v_mfma_f32_16x16x32_bf16 v[80:83], v[200:203], a[212:215], v[80:83]
    ds_read_b64_tr_b16 v[176:177], v17 offset:64
    v_mfma_f32_16x16x32_bf16 v[104:107], v[200:203], a[220:223], v[104:107]
    v_mfma_f32_16x16x32_bf16 v[128:131], v[200:203], a[228:231], v[128:131]
    ds_read_b64_tr_b16 v[178:179], v17 offset:832
    v_mfma_f32_16x16x32_bf16 v[152:155], v[200:203], a[236:239], v[152:155]
    buffer_load_dwordx4 v3, s[32:35], s53 offen offset:3072 sc1 lds
    s_add_u32 m0, m0, 4096
    s_add_u32 s53, s53, 4096
    v_mfma_f32_16x16x32_bf16 v[84:87], v[204:207], a[212:215], v[84:87]
    ds_read_b64_tr_b16 v[180:181], v16 offset:128
    v_mfma_f32_16x16x32_bf16 v[108:111], v[204:207], a[220:223], v[108:111]
    v_mfma_f32_16x16x32_bf16 v[132:135], v[204:207], a[228:231], v[132:135]
    ds_read_b64_tr_b16 v[182:183], v16 offset:896
    v_mfma_f32_16x16x32_bf16 v[156:159], v[204:207], a[236:239], v[156:159]
    buffer_load_dwordx4 v3, s[32:35], s53 offen sc1 lds
    v_mfma_f32_16x16x32_bf16 v[88:91], v[208:211], a[212:215], v[88:91]
    ds_read_b64_tr_b16 v[184:185], v17 offset:128
    v_mfma_f32_16x16x32_bf16 v[112:115], v[208:211], a[220:223], v[112:115]
    v_mfma_f32_16x16x32_bf16 v[136:139], v[208:211], a[228:231], v[136:139]
    ds_read_b64_tr_b16 v[186:187], v17 offset:896
    v_mfma_f32_16x16x32_bf16 v[160:163], v[208:211], a[236:239], v[160:163]
    buffer_load_dwordx4 v3, s[32:35], s53 offen offset:1024 sc1 lds
    s_waitcnt vmcnt(12) lgkmcnt(0)
    v_mfma_f32_16x16x32_bf16 v[68:71], v[164:167], a[240:243], v[68:71]
    ds_read_b64_tr_b16 v[188:189], v16 offset:6144
    v_mfma_f32_16x16x32_bf16 v[92:95], v[164:167], a[248:251], v[92:95]
    v_mfma_f32_16x16x32_bf16 v[116:119], v[164:167], a[0:3], v[116:119]
    s_add_u32 m0, s55, 0
    s_add_u32 s65, s54, 0
    ds_read_b64_tr_b16 v[190:191], v16 offset:6912
    v_mfma_f32_16x16x32_bf16 v[140:143], v[164:167], a[8:11], v[140:143]
    v_mfma_f32_16x16x32_bf16 v[72:75], v[168:171], a[240:243], v[72:75]
    ds_read_b64_tr_b16 v[192:193], v17 offset:6144
    v_mfma_f32_16x16x32_bf16 v[96:99], v[168:171], a[248:251], v[96:99]
    v_mfma_f32_16x16x32_bf16 v[120:123], v[168:171], a[0:3], v[120:123]
    ds_read_b64_tr_b16 v[194:195], v17 offset:6912
    v_mfma_f32_16x16x32_bf16 v[144:147], v[168:171], a[8:11], v[144:147]
    buffer_load_dwordx4 v232, s[24:27], s65 offen lds
    v_mfma_f32_16x16x32_bf16 v[76:79], v[172:175], a[240:243], v[76:79]
    ds_read_b64_tr_b16 v[196:197], v16 offset:6208
    v_mfma_f32_16x16x32_bf16 v[100:103], v[172:175], a[248:251], v[100:103]
    v_mfma_f32_16x16x32_bf16 v[124:127], v[172:175], a[0:3], v[124:127]
    s_add_u32 m0, s55, 1024
    s_add_u32 s65, s54, 0
    ds_read_b64_tr_b16 v[198:199], v16 offset:6976
    v_mfma_f32_16x16x32_bf16 v[148:151], v[172:175], a[8:11], v[148:151]
    v_mfma_f32_16x16x32_bf16 v[80:83], v[176:179], a[240:243], v[80:83]
    ds_read_b64_tr_b16 v[200:201], v17 offset:6208
    v_mfma_f32_16x16x32_bf16 v[104:107], v[176:179], a[248:251], v[104:107]
    v_mfma_f32_16x16x32_bf16 v[128:131], v[176:179], a[0:3], v[128:131]
    ds_read_b64_tr_b16 v[202:203], v17 offset:6976
    v_mfma_f32_16x16x32_bf16 v[152:155], v[176:179], a[8:11], v[152:155]
    buffer_load_dwordx4 v233, s[24:27], s65 offen lds
    v_mfma_f32_16x16x32_bf16 v[84:87], v[180:183], a[240:243], v[84:87]
    ds_read_b64_tr_b16 v[204:205], v16 offset:6272
    v_mfma_f32_16x16x32_bf16 v[108:111], v[180:183], a[248:251], v[108:111]
    v_mfma_f32_16x16x32_bf16 v[132:135], v[180:183], a[0:3], v[132:135]
    s_add_u32 m0, s55, 2048
    s_add_u32 s65, s54, 0
    ds_read_b64_tr_b16 v[206:207], v16 offset:7040
    v_mfma_f32_16x16x32_bf16 v[156:159], v[180:183], a[8:11], v[156:159]
    v_mfma_f32_16x16x32_bf16 v[88:91], v[184:187], a[240:243], v[88:91]
    ds_read_b64_tr_b16 v[208:209], v17 offset:6272
    v_mfma_f32_16x16x32_bf16 v[112:115], v[184:187], a[248:251], v[112:115]
    v_mfma_f32_16x16x32_bf16 v[136:139], v[184:187], a[0:3], v[136:139]
    ds_read_b64_tr_b16 v[210:211], v17 offset:7040
    v_mfma_f32_16x16x32_bf16 v[160:163], v[184:187], a[8:11], v[160:163]
    buffer_load_dwordx4 v234, s[24:27], s65 offen lds
    s_waitcnt vmcnt(9) lgkmcnt(0)
    v_mfma_f32_16x16x32_bf16 v[68:71], v[188:191], a[244:247], v[68:71]
    ds_read_b64_tr_b16 v[164:165], v16 offset:12288
    v_mfma_f32_16x16x32_bf16 v[92:95], v[188:191], a[252:255], v[92:95]
    v_mfma_f32_16x16x32_bf16 v[116:119], v[188:191], a[4:7], v[116:119]
    s_add_u32 m0, s55, 3072
    s_add_u32 s65, s54, 0
    ds_read_b64_tr_b16 v[166:167], v16 offset:13056
    v_mfma_f32_16x16x32_bf16 v[140:143], v[188:191], a[12:15], v[140:143]
    v_mfma_f32_16x16x32_bf16 v[72:75], v[192:195], a[244:247], v[72:75]
    ds_read_b64_tr_b16 v[168:169], v17 offset:12288
    v_mfma_f32_16x16x32_bf16 v[96:99], v[192:195], a[252:255], v[96:99]
    v_mfma_f32_16x16x32_bf16 v[120:123], v[192:195], a[4:7], v[120:123]
    ds_read_b64_tr_b16 v[170:171], v17 offset:13056
    v_mfma_f32_16x16x32_bf16 v[144:147], v[192:195], a[12:15], v[144:147]
    buffer_load_dwordx4 v235, s[24:27], s65 offen lds
    v_mfma_f32_16x16x32_bf16 v[76:79], v[196:199], a[244:247], v[76:79]
    ds_read_b64_tr_b16 v[172:173], v16 offset:12352
    v_mfma_f32_16x16x32_bf16 v[100:103], v[196:199], a[252:255], v[100:103]
    v_mfma_f32_16x16x32_bf16 v[124:127], v[196:199], a[4:7], v[124:127]
    s_add_u32 m0, s55, 4096
    s_add_u32 s65, s54, 0
    ds_read_b64_tr_b16 v[174:175], v16 offset:13120
    v_mfma_f32_16x16x32_bf16 v[148:151], v[196:199], a[12:15], v[148:151]
    v_mfma_f32_16x16x32_bf16 v[80:83], v[200:203], a[244:247], v[80:83]
    ds_read_b64_tr_b16 v[176:177], v17 offset:12352
    v_mfma_f32_16x16x32_bf16 v[104:107], v[200:203], a[252:255], v[104:107]
    v_mfma_f32_16x16x32_bf16 v[128:131], v[200:203], a[4:7], v[128:131]
    ds_read_b64_tr_b16 v[178:179], v17 offset:13120
    v_mfma_f32_16x16x32_bf16 v[152:155], v[200:203], a[12:15], v[152:155]
    buffer_load_dwordx4 v238, s[24:27], s65 offen lds
    v_mfma_f32_16x16x32_bf16 v[84:87], v[204:207], a[244:247], v[84:87]
    ds_read_b64_tr_b16 v[180:181], v16 offset:12416
    v_mfma_f32_16x16x32_bf16 v[108:111], v[204:207], a[252:255], v[108:111]
    v_mfma_f32_16x16x32_bf16 v[132:135], v[204:207], a[4:7], v[132:135]
    s_add_u32 m0, s55, 5120
    s_add_u32 s65, s54, 40960
    ds_read_b64_tr_b16 v[182:183], v16 offset:13184
    v_mfma_f32_16x16x32_bf16 v[156:159], v[204:207], a[12:15], v[156:159]
    v_mfma_f32_16x16x32_bf16 v[88:91], v[208:211], a[244:247], v[88:91]
    ds_read_b64_tr_b16 v[184:185], v17 offset:12416
    v_mfma_f32_16x16x32_bf16 v[112:115], v[208:211], a[252:255], v[112:115]
    v_mfma_f32_16x16x32_bf16 v[136:139], v[208:211], a[4:7], v[136:139]
    ds_read_b64_tr_b16 v[186:187], v17 offset:13184
    v_mfma_f32_16x16x32_bf16 v[160:163], v[208:211], a[12:15], v[160:163]
    buffer_load_dwordx4 v232, s[24:27], s65 offen lds
    s_waitcnt vmcnt(6) lgkmcnt(0)
    v_mfma_f32_16x16x32_bf16 v[92:95], v[164:167], a[24:27], v[92:95]
    ds_read_b64_tr_b16 v[188:189], v16 offset:18432
    ds_read_b64_tr_b16 v[190:191], v16 offset:19200
    v_mfma_f32_16x16x32_bf16 v[96:99], v[168:171], a[24:27], v[96:99]
    ds_read_b64_tr_b16 v[192:193], v17 offset:18432
    ds_read_b64_tr_b16 v[194:195], v17 offset:19200
    v_mfma_f32_16x16x32_bf16 v[100:103], v[172:175], a[24:27], v[100:103]
    ds_read_b64_tr_b16 v[196:197], v16 offset:18496
    ds_read_b64_tr_b16 v[198:199], v16 offset:19264
    v_mfma_f32_16x16x32_bf16 v[104:107], v[176:179], a[24:27], v[104:107]
    s_add_u32 m0, s55, 6144
    s_add_u32 s65, s54, 40960
    ds_read_b64_tr_b16 v[200:201], v17 offset:18496
    ds_read_b64_tr_b16 v[202:203], v17 offset:19264
    v_mfma_f32_16x16x32_bf16 v[108:111], v[180:183], a[24:27], v[108:111]
    ds_read_b64_tr_b16 v[204:205], v16 offset:18560
    ds_read_b64_tr_b16 v[206:207], v16 offset:19328
    v_mfma_f32_16x16x32_bf16 v[112:115], v[184:187], a[24:27], v[112:115]
    ds_read_b64_tr_b16 v[208:209], v17 offset:18560
    ds_read_b64_tr_b16 v[210:211], v17 offset:19328
    buffer_load_dwordx4 v233, s[24:27], s65 offen lds
    s_waitcnt lgkmcnt(0)
    s_barrier
    v_mfma_f32_16x16x32_bf16 v[92:95], v[188:191], a[28:31], v[92:95]
    s_add_u32 m0, s55, 7168
    s_add_u32 s65, s54, 40960
    v_mfma_f32_16x16x32_bf16 v[96:99], v[192:195], a[28:31], v[96:99]
    v_mfma_f32_16x16x32_bf16 v[100:103], v[196:199], a[28:31], v[100:103]
    v_mfma_f32_16x16x32_bf16 v[104:107], v[200:203], a[28:31], v[104:107]
    v_mfma_f32_16x16x32_bf16 v[108:111], v[204:207], a[28:31], v[108:111]
    v_mfma_f32_16x16x32_bf16 v[112:115], v[208:211], a[28:31], v[112:115]
    v_mfma_f32_16x16x32_bf16 v[116:119], v[164:167], a[32:35], v[116:119]
    v_mfma_f32_16x16x32_bf16 v[120:123], v[168:171], a[32:35], v[120:123]
    v_mfma_f32_16x16x32_bf16 v[124:127], v[172:175], a[32:35], v[124:127]
    buffer_load_dwordx4 v234, s[24:27], s65 offen lds
    v_mfma_f32_16x16x32_bf16 v[128:131], v[176:179], a[32:35], v[128:131]
    v_cvt_pk_bf16_f32 v92, v92, v93
    v_cvt_pk_bf16_f32 v93, v94, v95
    v_mfma_f32_16x16x32_bf16 v[132:135], v[180:183], a[32:35], v[132:135]
    v_cvt_pk_bf16_f32 v94, v96, v97
    v_cvt_pk_bf16_f32 v95, v98, v99
    v_mfma_f32_16x16x32_bf16 v[136:139], v[184:187], a[32:35], v[136:139]
    ds_write_b128 v18, v[92:95] offset:0
    v_cvt_pk_bf16_f32 v100, v100, v101
    v_mfma_f32_16x16x32_bf16 v[116:119], v[188:191], a[36:39], v[116:119]
    s_add_u32 m0, s55, 8192
    s_add_u32 s65, s54, 40960
    v_cvt_pk_bf16_f32 v101, v102, v103
    v_cvt_pk_bf16_f32 v102, v104, v105
    v_mfma_f32_16x16x32_bf16 v[120:123], v[192:195], a[36:39], v[120:123]
    v_cvt_pk_bf16_f32 v103, v106, v107
    ds_write_b128 v18, v[100:103] offset:1024
    v_mfma_f32_16x16x32_bf16 v[124:127], v[196:199], a[36:39], v[124:127]
    v_cvt_pk_bf16_f32 v108, v108, v109
    v_cvt_pk_bf16_f32 v109, v110, v111
    buffer_load_dwordx4 v235, s[24:27], s65 offen lds
    v_mfma_f32_16x16x32_bf16 v[128:131], v[200:203], a[36:39], v[128:131]
    s_add_u32 m0, s55, 9216
    s_add_u32 s65, s54, 40960
    v_cvt_pk_bf16_f32 v110, v112, v113
    v_cvt_pk_bf16_f32 v111, v114, v115
    v_mfma_f32_16x16x32_bf16 v[132:135], v[204:207], a[36:39], v[132:135]
    ds_write_b128 v18, v[108:111] offset:2048
    v_mfma_f32_16x16x32_bf16 v[136:139], v[208:211], a[36:39], v[136:139]
    v_mfma_f32_16x16x32_bf16 v[140:143], v[164:167], a[40:43], v[140:143]
    v_mfma_f32_16x16x32_bf16 v[144:147], v[168:171], a[40:43], v[144:147]
    v_mfma_f32_16x16x32_bf16 v[148:151], v[172:175], a[40:43], v[148:151]
    buffer_load_dwordx4 v238, s[24:27], s65 offen lds
    v_mfma_f32_16x16x32_bf16 v[152:155], v[176:179], a[40:43], v[152:155]
    v_cvt_pk_bf16_f32 v116, v116, v117
    v_cvt_pk_bf16_f32 v117, v118, v119
    v_mfma_f32_16x16x32_bf16 v[156:159], v[180:183], a[40:43], v[156:159]
    v_cvt_pk_bf16_f32 v118, v120, v121
    v_cvt_pk_bf16_f32 v119, v122, v123
    v_mfma_f32_16x16x32_bf16 v[160:163], v[184:187], a[40:43], v[160:163]
    ds_write_b128 v19, v[116:119] offset:0
    v_cvt_pk_bf16_f32 v124, v124, v125
    v_mfma_f32_16x16x32_bf16 v[140:143], v[188:191], a[44:47], v[140:143]
    s_add_u32 m0, s55, 10240
    s_add_u32 s65, s54, 81920
    v_cvt_pk_bf16_f32 v125, v126, v127
    v_cvt_pk_bf16_f32 v126, v128, v129
    v_mfma_f32_16x16x32_bf16 v[144:147], v[192:195], a[44:47], v[144:147]
    v_cvt_pk_bf16_f32 v127, v130, v131
    ds_write_b128 v19, v[124:127] offset:1024
    v_mfma_f32_16x16x32_bf16 v[148:151], v[196:199], a[44:47], v[148:151]
    v_cvt_pk_bf16_f32 v132, v132, v133
    v_cvt_pk_bf16_f32 v133, v134, v135
    buffer_load_dwordx4 v232, s[24:27], s65 offen lds
    v_mfma_f32_16x16x32_bf16 v[152:155], v[200:203], a[44:47], v[152:155]
    s_add_u32 m0, s55, 11264
    s_add_u32 s65, s54, 81920
    v_cvt_pk_bf16_f32 v134, v136, v137
    v_cvt_pk_bf16_f32 v135, v138, v139
    v_mfma_f32_16x16x32_bf16 v[156:159], v[204:207], a[44:47], v[156:159]
    ds_write_b128 v19, v[132:135] offset:2048
    v_mfma_f32_16x16x32_bf16 v[160:163], v[208:211], a[44:47], v[160:163]
    v_mfma_f32_16x16x32_bf16 v[68:71], v[164:167], a[16:19], v[68:71]
    v_mfma_f32_16x16x32_bf16 v[72:75], v[168:171], a[16:19], v[72:75]
    v_mfma_f32_16x16x32_bf16 v[76:79], v[172:175], a[16:19], v[76:79]
    buffer_load_dwordx4 v233, s[24:27], s65 offen lds
    v_mfma_f32_16x16x32_bf16 v[80:83], v[176:179], a[16:19], v[80:83]
    v_cvt_pk_bf16_f32 v140, v140, v141
    v_cvt_pk_bf16_f32 v141, v142, v143
    v_mfma_f32_16x16x32_bf16 v[84:87], v[180:183], a[16:19], v[84:87]
    v_cvt_pk_bf16_f32 v142, v144, v145
    v_cvt_pk_bf16_f32 v143, v146, v147
    v_mfma_f32_16x16x32_bf16 v[88:91], v[184:187], a[16:19], v[88:91]
    ds_write_b128 v35, v[140:143] offset:0
    v_cvt_pk_bf16_f32 v148, v148, v149
    v_mfma_f32_16x16x32_bf16 v[68:71], v[188:191], a[20:23], v[68:71]
    s_add_u32 m0, s55, 12288
    s_add_u32 s65, s54, 81920
    v_cvt_pk_bf16_f32 v149, v150, v151
    v_cvt_pk_bf16_f32 v150, v152, v153
    v_mfma_f32_16x16x32_bf16 v[72:75], v[192:195], a[20:23], v[72:75]
    v_cvt_pk_bf16_f32 v151, v154, v155
    ds_write_b128 v35, v[148:151] offset:1024
    v_mfma_f32_16x16x32_bf16 v[76:79], v[196:199], a[20:23], v[76:79]
    v_cvt_pk_bf16_f32 v156, v156, v157
    v_cvt_pk_bf16_f32 v157, v158, v159
    buffer_load_dwordx4 v234, s[24:27], s65 offen lds
    v_mfma_f32_16x16x32_bf16 v[80:83], v[200:203], a[20:23], v[80:83]
    v_cvt_pk_bf16_f32 v158, v160, v161
    v_cvt_pk_bf16_f32 v159, v162, v163
    v_mfma_f32_16x16x32_bf16 v[84:87], v[204:207], a[20:23], v[84:87]
    ds_write_b128 v35, v[156:159] offset:2048
    v_mfma_f32_16x16x32_bf16 v[88:91], v[208:211], a[20:23], v[88:91]
    s_waitcnt lgkmcnt(0)
    s_barrier
    ds_read_b128 v[92:95], v34 offset:0
    ds_read_b128 v[96:99], v34 offset:1024
    ds_read_b128 v[100:103], v34 offset:2048
    s_add_u32 m0, s55, 13312
    s_add_u32 s65, s54, 81920
    ds_read_b128 v[104:107], v34 offset:3072
    ds_read_b128 v[108:111], v34 offset:4096
    ds_read_b128 v[112:115], v34 offset:5120
    ds_read_b128 v[116:119], v34 offset:6144
    ds_read_b128 v[120:123], v34 offset:7168
    ds_read_b128 v[124:127], v34 offset:8192
    s_mov_b32 s84, 0x3f80
    s_mov_b32 s85, 0x3f800000
    buffer_load_dwordx4 v235, s[24:27], s65 offen lds
    s_waitcnt lgkmcnt(6)
    v_dot2c_f32_bf16 v68, s84, v92
    v_dot2c_f32_bf16 v69, s85, v92
    v_dot2c_f32_bf16 v70, s84, v93
    v_dot2c_f32_bf16 v71, s85, v93
    v_dot2c_f32_bf16 v72, s84, v94
    v_dot2c_f32_bf16 v73, s85, v94
    v_dot2c_f32_bf16 v74, s84, v95
    v_dot2c_f32_bf16 v75, s85, v95
    v_dot2c_f32_bf16 v76, s84, v96
    v_dot2c_f32_bf16 v77, s85, v96
    v_dot2c_f32_bf16 v78, s84, v97
    v_dot2c_f32_bf16 v79, s85, v97
    v_dot2c_f32_bf16 v80, s84, v98
    v_dot2c_f32_bf16 v81, s85, v98
    v_dot2c_f32_bf16 v82, s84, v99
    v_dot2c_f32_bf16 v83, s85, v99
    v_dot2c_f32_bf16 v84, s84, v100
    v_dot2c_f32_bf16 v85, s85, v100
    v_dot2c_f32_bf16 v86, s84, v101
    v_dot2c_f32_bf16 v87, s85, v101
    v_dot2c_f32_bf16 v88, s84, v102
    v_dot2c_f32_bf16 v89, s85, v102
    v_dot2c_f32_bf16 v90, s84, v103
    v_dot2c_f32_bf16 v91, s85, v103
    s_waitcnt lgkmcnt(3)
    v_dot2c_f32_bf16 v68, s84, v104
    v_dot2c_f32_bf16 v69, s85, v104
    v_dot2c_f32_bf16 v70, s84, v105
    v_dot2c_f32_bf16 v71, s85, v105
    v_dot2c_f32_bf16 v72, s84, v106
    v_dot2c_f32_bf16 v73, s85, v106
    s_add_u32 m0, s55, 14336
    s_add_u32 s65, s54, 81920
    v_dot2c_f32_bf16 v74, s84, v107
    v_dot2c_f32_bf16 v75, s85, v107
    v_dot2c_f32_bf16 v76, s84, v108
    v_dot2c_f32_bf16 v77, s85, v108
    v_dot2c_f32_bf16 v78, s84, v109
    v_dot2c_f32_bf16 v79, s85, v109
    v_dot2c_f32_bf16 v80, s84, v110
    v_dot2c_f32_bf16 v81, s85, v110
    buffer_load_dwordx4 v238, s[24:27], s65 offen lds
    v_dot2c_f32_bf16 v82, s84, v111
    v_dot2c_f32_bf16 v83, s85, v111
    v_dot2c_f32_bf16 v84, s84, v112
    v_dot2c_f32_bf16 v85, s85, v112
    v_dot2c_f32_bf16 v86, s84, v113
    v_dot2c_f32_bf16 v87, s85, v113
    v_dot2c_f32_bf16 v88, s84, v114
    v_dot2c_f32_bf16 v89, s85, v114
    v_dot2c_f32_bf16 v90, s84, v115
    v_dot2c_f32_bf16 v91, s85, v115
    s_waitcnt lgkmcnt(0)
    v_dot2c_f32_bf16 v68, s84, v116
    v_dot2c_f32_bf16 v69, s85, v116
    v_dot2c_f32_bf16 v70, s84, v117
    v_dot2c_f32_bf16 v71, s85, v117
    v_dot2c_f32_bf16 v72, s84, v118
    v_dot2c_f32_bf16 v73, s85, v118
    v_dot2c_f32_bf16 v74, s84, v119
    v_dot2c_f32_bf16 v75, s85, v119
    v_dot2c_f32_bf16 v76, s84, v120
    v_dot2c_f32_bf16 v77, s85, v120
    v_dot2c_f32_bf16 v78, s84, v121
    v_dot2c_f32_bf16 v79, s85, v121
    v_dot2c_f32_bf16 v80, s84, v122
    v_dot2c_f32_bf16 v81, s85, v122
    v_dot2c_f32_bf16 v82, s84, v123
    v_dot2c_f32_bf16 v83, s85, v123
    v_dot2c_f32_bf16 v84, s84, v124
    v_dot2c_f32_bf16 v85, s85, v124
    v_dot2c_f32_bf16 v86, s84, v125
    v_dot2c_f32_bf16 v87, s85, v125
    v_dot2c_f32_bf16 v88, s84, v126
    v_dot2c_f32_bf16 v89, s85, v126
    v_dot2c_f32_bf16 v90, s84, v127
    v_dot2c_f32_bf16 v91, s85, v127
    s_nop 1
    v_pk_fma_f32 v[68:69], v[68:69], v[32:33], v[32:33] op_sel:[0,0,1] op_sel_hi:[1,0,1]
    v_pk_fma_f32 v[70:71], v[70:71], v[32:33], v[32:33] op_sel:[0,0,1] op_sel_hi:[1,0,1]
    v_pk_fma_f32 v[72:73], v[72:73], v[32:33], v[32:33] op_sel:[0,0,1] op_sel_hi:[1,0,1]
    v_pk_fma_f32 v[74:75], v[74:75], v[32:33], v[32:33] op_sel:[0,0,1] op_sel_hi:[1,0,1]
    v_pk_fma_f32 v[76:77], v[76:77], v[32:33], v[32:33] op_sel:[0,0,1] op_sel_hi:[1,0,1]
    v_pk_fma_f32 v[78:79], v[78:79], v[32:33], v[32:33] op_sel:[0,0,1] op_sel_hi:[1,0,1]
    v_pk_fma_f32 v[80:81], v[80:81], v[32:33], v[32:33] op_sel:[0,0,1] op_sel_hi:[1,0,1]
    v_pk_fma_f32 v[82:83], v[82:83], v[32:33], v[32:33] op_sel:[0,0,1] op_sel_hi:[1,0,1]
    v_pk_fma_f32 v[84:85], v[84:85], v[32:33], v[32:33] op_sel:[0,0,1] op_sel_hi:[1,0,1]
    v_pk_fma_f32 v[86:87], v[86:87], v[32:33], v[32:33] op_sel:[0,0,1] op_sel_hi:[1,0,1]
    v_pk_fma_f32 v[88:89], v[88:89], v[32:33], v[32:33] op_sel:[0,0,1] op_sel_hi:[1,0,1]
    v_pk_fma_f32 v[90:91], v[90:91], v[32:33], v[32:33] op_sel:[0,0,1] op_sel_hi:[1,0,1]
    v_pk_mul_f32 v[68:69], v[68:69], v[44:45]
    v_pk_mul_f32 v[70:71], v[70:71], v[46:47]
    v_pk_mul_f32 v[72:73], v[72:73], v[48:49]
    v_pk_mul_f32 v[74:75], v[74:75], v[50:51]
    v_pk_mul_f32 v[76:77], v[76:77], v[52:53]
    v_pk_mul_f32 v[78:79], v[78:79], v[54:55]
    v_pk_mul_f32 v[80:81], v[80:81], v[56:57]
    v_pk_mul_f32 v[82:83], v[82:83], v[58:59]
    v_pk_mul_f32 v[84:85], v[84:85], v[60:61]
    v_pk_mul_f32 v[86:87], v[86:87], v[62:63]
    v_pk_mul_f32 v[88:89], v[88:89], v[64:65]
    v_pk_mul_f32 v[90:91], v[90:91], v[66:67]
    s_mul_i32 s52, s47, 24
    s_mul_i32 s53, s48, 3
    s_add_u32 s53, s52, s53
    s_lshl_b32 s53, s53, 2
    s_add_u32 s53, s53, s44
    s_lshl_b32 s53, s53, 10
    s_add_u32 s53, s53, 0x800000
    v_cvt_pk_bf16_f32 v44, v68, v69
    v_cvt_pk_bf16_f32 v45, v70, v71
    v_cvt_pk_bf16_f32 v46, v72, v73
    v_cvt_pk_bf16_f32 v47, v74, v75
    v_cvt_pk_bf16_f32 v48, v76, v77
    v_cvt_pk_bf16_f32 v49, v78, v79
    v_cvt_pk_bf16_f32 v50, v80, v81
    v_cvt_pk_bf16_f32 v51, v82, v83
    v_cvt_pk_bf16_f32 v52, v84, v85
    v_cvt_pk_bf16_f32 v53, v86, v87
    v_cvt_pk_bf16_f32 v54, v88, v89
    v_cvt_pk_bf16_f32 v55, v90, v91
    s_add_u32 m0, s55, 61440
    s_add_u32 s65, s54, 245760
    buffer_store_dwordx4 v[44:47], v3, s[32:35], s53 offen sc1
    s_add_u32 s53, s53, 4096
    buffer_store_dwordx4 v[48:51], v3, s[32:35], s53 offen sc1
    s_add_u32 s53, s53, 4096
    buffer_store_dwordx4 v[52:55], v3, s[32:35], s53 offen sc1
    s_add_u32 s53, s53, 4096
    s_waitcnt vmcnt(3)
    s_barrier
    buffer_load_dwordx4 v232, s[24:27], s65 offen lds
    s_add_u32 m0, s55, 62464
    s_add_u32 s65, s54, 245760
    ds_read_b64_tr_b16 a[0:1], v239 offset:0
    ds_read_b64_tr_b16 a[2:3], v239 offset:2560
    ds_read_b64_tr_b16 a[4:5], v239 offset:8
    ds_read_b64_tr_b16 a[6:7], v239 offset:2568
    ds_read_b64_tr_b16 a[8:9], v239 offset:64
    ds_read_b64_tr_b16 a[10:11], v239 offset:2624
    ds_read_b64_tr_b16 a[12:13], v239 offset:72
    buffer_load_dwordx4 v233, s[24:27], s65 offen lds
    s_add_u32 m0, s55, 63488
    s_add_u32 s65, s54, 245760
    ds_read_b64_tr_b16 a[14:15], v239 offset:2632
    ds_read_b64_tr_b16 a[16:17], v240 offset:128
    ds_read_b64_tr_b16 a[18:19], v240 offset:2688
    s_waitcnt lgkmcnt(5)
    ds_read_b64_tr_b16 a[20:21], v239 offset:5120
    ds_read_b64_tr_b16 a[22:23], v239 offset:7680
    ds_read_b64_tr_b16 a[24:25], v239 offset:5128
    buffer_load_dwordx4 v234, s[24:27], s65 offen lds
    s_add_u32 m0, s55, 64512
    s_add_u32 s65, s54, 245760
    ds_read_b64_tr_b16 a[26:27], v239 offset:7688
    ds_read_b64_tr_b16 a[28:29], v239 offset:5184
    ds_read_b64_tr_b16 a[30:31], v239 offset:7744
    ds_read_b64_tr_b16 a[32:33], v239 offset:5192
    ds_read_b64_tr_b16 a[34:35], v239 offset:7752
    ds_read_b64_tr_b16 a[36:37], v240 offset:5248
    ds_read_b64_tr_b16 a[38:39], v240 offset:7808
    buffer_load_dwordx4 v235, s[24:27], s65 offen lds
    s_add_u32 m0, s55, 65536
    s_add_u32 s65, s54, 245760
    s_waitcnt lgkmcnt(5)
    ds_read_b64_tr_b16 a[40:41], v239 offset:10240
    ds_read_b64_tr_b16 a[42:43], v239 offset:12800
    ds_read_b64_tr_b16 a[44:45], v239 offset:10248
    ds_read_b64_tr_b16 a[46:47], v239 offset:12808
    ds_read_b64_tr_b16 a[48:49], v239 offset:10304
    ds_read_b64_tr_b16 a[50:51], v239 offset:12864
    buffer_load_dwordx4 v238, s[24:27], s65 offen lds
    s_add_u32 m0, s55, 66560
    s_add_u32 s65, s54, 286720
    ds_read_b64_tr_b16 a[52:53], v239 offset:10312
    ds_read_b64_tr_b16 a[54:55], v239 offset:12872
    ds_read_b64_tr_b16 a[56:57], v240 offset:10368
    ds_read_b64_tr_b16 a[58:59], v240 offset:12928
    s_waitcnt lgkmcnt(5)
    ds_read_b64_tr_b16 a[60:61], v239 offset:15360
    ds_read_b64_tr_b16 a[62:63], v239 offset:17920
    buffer_load_dwordx4 v232, s[24:27], s65 offen lds
    s_add_u32 m0, s55, 67584
    s_add_u32 s65, s54, 286720
    ds_read_b64_tr_b16 a[64:65], v239 offset:15368
    ds_read_b64_tr_b16 a[66:67], v239 offset:17928
    ds_read_b64_tr_b16 a[68:69], v239 offset:15424
    ds_read_b64_tr_b16 a[70:71], v239 offset:17984
    ds_read_b64_tr_b16 a[72:73], v239 offset:15432
    ds_read_b64_tr_b16 a[74:75], v239 offset:17992
    ds_read_b64_tr_b16 a[76:77], v240 offset:15488
    buffer_load_dwordx4 v233, s[24:27], s65 offen lds
    s_add_u32 m0, s55, 68608
    s_add_u32 s65, s54, 286720
    ds_read_b64_tr_b16 a[78:79], v240 offset:18048
    s_waitcnt lgkmcnt(5)
    ds_read_b64_tr_b16 a[80:81], v239 offset:20480
    ds_read_b64_tr_b16 a[82:83], v239 offset:23040
    ds_read_b64_tr_b16 a[84:85], v239 offset:20488
    ds_read_b64_tr_b16 a[86:87], v239 offset:23048
    ds_read_b64_tr_b16 a[88:89], v239 offset:20544
    buffer_load_dwordx4 v234, s[24:27], s65 offen lds
    s_add_u32 m0, s55, 69632
    s_add_u32 s65, s54, 286720
    ds_read_b64_tr_b16 a[90:91], v239 offset:23104
    ds_read_b64_tr_b16 a[92:93], v239 offset:20552
    ds_read_b64_tr_b16 a[94:95], v239 offset:23112
    ds_read_b64_tr_b16 a[96:97], v240 offset:20608
    ds_read_b64_tr_b16 a[98:99], v240 offset:23168
    s_waitcnt lgkmcnt(5)
    ds_read_b64_tr_b16 a[100:101], v239 offset:25600
    buffer_load_dwordx4 v235, s[24:27], s65 offen lds
    s_add_u32 m0, s55, 70656
    s_add_u32 s65, s54, 286720
    ds_read_b64_tr_b16 a[102:103], v239 offset:28160
    ds_read_b64_tr_b16 a[104:105], v239 offset:25608
    ds_read_b64_tr_b16 a[106:107], v239 offset:28168
    ds_read_b64_tr_b16 a[108:109], v239 offset:25664
    ds_read_b64_tr_b16 a[110:111], v239 offset:28224
    ds_read_b64_tr_b16 a[112:113], v239 offset:25672
    ds_read_b64_tr_b16 a[114:115], v239 offset:28232
    buffer_load_dwordx4 v238, s[24:27], s65 offen lds
    ds_read_b64_tr_b16 a[116:117], v240 offset:25728
    ds_read_b64_tr_b16 a[118:119], v240 offset:28288
    s_waitcnt lgkmcnt(5)
    s_waitcnt vmcnt(10)
    s_lshl_b32 s98, s47, 3
    s_add_u32 s98, s98, s48
    s_lshl_b32 s98, s98, 2
    s_add_u32 m0, s55, 71680
    s_add_u32 s65, s54, 327680
    s_add_u32 s98, s98, s44
    s_lshl_b32 s98, s98, 7
    s_add_u32 s98, s98, 0xd20000
    v_mov_b32 v4, s49
    v_mov_b32 v5, 0
    s_mov_b64 exec, 1
    buffer_store_dword v4, v5, s[32:35], s98 offen sc1
    s_mov_b64 exec, -1
    buffer_load_dwordx4 v232, s[24:27], s65 offen lds
    s_add_u32 m0, s55, 72704
    s_add_u32 s65, s54, 327680
    buffer_load_dwordx4 v233, s[24:27], s65 offen lds
    s_add_u32 m0, s55, 73728
    s_add_u32 s65, s54, 327680
    buffer_load_dwordx4 v234, s[24:27], s65 offen lds
    s_add_u32 m0, s55, 74752
    s_add_u32 s65, s54, 327680
    buffer_load_dwordx4 v235, s[24:27], s65 offen lds
    s_add_u32 m0, s55, 75776
    s_add_u32 s65, s54, 327680
    buffer_load_dwordx4 v238, s[24:27], s65 offen lds
    s_lshl_b32 s85, s47, 3
    s_lshl_b32 s53, s50, 2
    s_add_u32 s85, s85, s53
    s_lshl_b32 s85, s85, 9
    s_lshl_b32 s53, s51, 8
    s_add_u32 s85, s85, s53
    s_add_u32 s85, s85, 0xd20000
    v_lshrrev_b32 v4, 1, v0
    v_lshlrev_b32 v4, 9, v4
    v_and_b32 v5, 1, v0
    v_lshl_add_u32 v4, v5, 7, v4
    s_mov_b64 exec, 0xff
    buffer_load_dword v36, v4, s[32:35], s85 offen sc1
    s_mov_b64 exec, -1
    s_mul_i32 s53, s50, 12
    s_add_u32 s52, s52, s53
    s_lshl_b32 s52, s52, 12
    s_add_u32 s52, s52, 0x800000
    s_xor_b32 s84, s44, 1
    s_mul_i32 s84, s84, 5120
    s_add_u32 s84, s84, 122880
    v_add_u32 v6, s84, v3
    s_mul_i32 s84, s44, 5120
    s_add_u32 s84, s84, 122880
    v_add_u32 v7, s84, v3
    v_mul_u32_u24 v16, 1280, v13
    v_lshl_add_u32 v17, v2, 3, v16
    v_lshl_add_u32 v16, v2, 4, v16
    s_mul_i32 s54, s48, 160
    s_lshl_b32 s53, s44, 10
    v_add_u32 v18, s53, v3
    v_xor_b32 v19, 1024, v18
    s_mov_b64 exec, 0xff
    s_mov_b32 s84, 0x4000
    s_waitcnt vmcnt(0)
    s_branch L_pe_chk
L_pe:
    buffer_load_dword v36, v4, s[32:35], s85 offen sc1
    s_waitcnt vmcnt(0)
L_pe_chk:
    v_xor_b32 v36, s49, v36
    v_cmp_ne_u32 vcc, 0, v36
    s_cbranch_vccz L_pe_ok
    s_sleep 2
    s_sub_u32 s84, s84, 1
    s_cmp_lg_u32 s84, 0
    s_cbranch_scc1 L_pe
L_pe_ok:
    s_mov_b64 exec, -1
    buffer_load_dwordx4 v[72:75], v19, s[32:35], s52 offen sc1
    buffer_load_dwordx4 v[68:71], v18, s[32:35], s52 offen sc1
    s_add_u32 s52, s52, 4096
    buffer_load_dwordx4 v[80:83], v19, s[32:35], s52 offen sc1
    buffer_load_dwordx4 v[76:79], v18, s[32:35], s52 offen sc1
    s_add_u32 s52, s52, 4096
    buffer_load_dwordx4 v[88:91], v19, s[32:35], s52 offen sc1
    buffer_load_dwordx4 v[84:87], v18, s[32:35], s52 offen sc1
    s_add_u32 s52, s52, 4096
    buffer_load_dwordx4 v[96:99], v19, s[32:35], s52 offen sc1
    buffer_load_dwordx4 v[92:95], v18, s[32:35], s52 offen sc1
    s_add_u32 s52, s52, 4096
    s_barrier
    s_waitcnt vmcnt(6) lgkmcnt(0)
    v_mfma_f32_16x16x32_bf16 v[184:187], a[0:3], v[72:75], 0
    buffer_load_dwordx4 v[104:107], v19, s[32:35], s52 offen sc1
    buffer_load_dwordx4 v[100:103], v18, s[32:35], s52 offen sc1
    v_mfma_f32_16x16x32_bf16 v[188:191], a[4:7], v[72:75], 0
    s_add_u32 s52, s52, 4096
    ds_read_b64_tr_b16 a[120:121], v241 offset:0
    v_mfma_f32_16x16x32_bf16 v[192:195], a[8:11], v[72:75], 0
    ds_read_b64_tr_b16 a[122:123], v241 offset:2560
    ds_read_b64_tr_b16 a[124:125], v241 offset:8
    v_mfma_f32_16x16x32_bf16 v[196:199], a[12:15], v[72:75], 0
    ds_read_b64_tr_b16 a[126:127], v241 offset:2568
    ds_read_b64_tr_b16 a[128:129], v241 offset:64
    v_mfma_f32_16x16x32_bf16 v[200:203], a[16:19], v[72:75], 0
    ds_read_b64_tr_b16 a[130:131], v241 offset:2624
    ds_read_b64_tr_b16 a[132:133], v241 offset:72
    v_mfma_f32_16x16x32_bf16 v[164:167], a[0:3], v[68:71], v[212:215]
    ds_read_b64_tr_b16 a[134:135], v241 offset:2632
    ds_read_b64_tr_b16 a[136:137], v248 offset:128
    v_mfma_f32_16x16x32_bf16 v[168:171], a[4:7], v[68:71], v[216:219]
    ds_read_b64_tr_b16 a[138:139], v248 offset:2688
    v_mfma_f32_16x16x32_bf16 v[172:175], a[8:11], v[68:71], v[220:223]
    v_mfma_f32_16x16x32_bf16 v[176:179], a[12:15], v[68:71], v[224:227]
    v_mfma_f32_16x16x32_bf16 v[180:183], a[16:19], v[68:71], v[228:231]
    s_waitcnt vmcnt(6) lgkmcnt(5)
    v_mfma_f32_16x16x32_bf16 v[184:187], a[20:23], v[80:83], v[184:187]
    buffer_load_dwordx4 v[112:115], v19, s[32:35], s52 offen sc1
    buffer_load_dwordx4 v[108:111], v18, s[32:35], s52 offen sc1
    v_mfma_f32_16x16x32_bf16 v[188:191], a[24:27], v[80:83], v[188:191]
    s_add_u32 s52, s52, 4096
    ds_read_b64_tr_b16 a[140:141], v241 offset:5120
    v_mfma_f32_16x16x32_bf16 v[192:195], a[28:31], v[80:83], v[192:195]
    ds_read_b64_tr_b16 a[142:143], v241 offset:7680
    ds_read_b64_tr_b16 a[144:145], v241 offset:5128
    v_mfma_f32_16x16x32_bf16 v[196:199], a[32:35], v[80:83], v[196:199]
    ds_read_b64_tr_b16 a[146:147], v241 offset:7688
    ds_read_b64_tr_b16 a[148:149], v241 offset:5184
    v_mfma_f32_16x16x32_bf16 v[200:203], a[36:39], v[80:83], v[200:203]
    ds_read_b64_tr_b16 a[150:151], v241 offset:7744
    ds_read_b64_tr_b16 a[152:153], v241 offset:5192
    v_mfma_f32_16x16x32_bf16 v[164:167], a[20:23], v[76:79], v[164:167]
    ds_read_b64_tr_b16 a[154:155], v241 offset:7752
    ds_read_b64_tr_b16 a[156:157], v248 offset:5248
    v_mfma_f32_16x16x32_bf16 v[168:171], a[24:27], v[76:79], v[168:171]
    ds_read_b64_tr_b16 a[158:159], v248 offset:7808
    v_mfma_f32_16x16x32_bf16 v[172:175], a[28:31], v[76:79], v[172:175]
    v_mfma_f32_16x16x32_bf16 v[176:179], a[32:35], v[76:79], v[176:179]
    v_mfma_f32_16x16x32_bf16 v[180:183], a[36:39], v[76:79], v[180:183]
    s_waitcnt vmcnt(6) lgkmcnt(5)
    v_mfma_f32_16x16x32_bf16 v[184:187], a[40:43], v[88:91], v[184:187]
    buffer_load_dwordx4 v[120:123], v19, s[32:35], s52 offen sc1
    buffer_load_dwordx4 v[116:119], v18, s[32:35], s52 offen sc1
    v_mfma_f32_16x16x32_bf16 v[188:191], a[44:47], v[88:91], v[188:191]
    s_add_u32 s52, s52, 4096
    ds_read_b64_tr_b16 a[160:161], v241 offset:10240
    v_mfma_f32_16x16x32_bf16 v[192:195], a[48:51], v[88:91], v[192:195]
    ds_read_b64_tr_b16 a[162:163], v241 offset:12800
    ds_read_b64_tr_b16 a[164:165], v241 offset:10248
    v_mfma_f32_16x16x32_bf16 v[196:199], a[52:55], v[88:91], v[196:199]
    ds_read_b64_tr_b16 a[166:167], v241 offset:12808
    ds_read_b64_tr_b16 a[168:169], v241 offset:10304
    v_mfma_f32_16x16x32_bf16 v[200:203], a[56:59], v[88:91], v[200:203]
    ds_read_b64_tr_b16 a[170:171], v241 offset:12864
    ds_read_b64_tr_b16 a[172:173], v241 offset:10312
    v_mfma_f32_16x16x32_bf16 v[164:167], a[40:43], v[84:87], v[164:167]
    ds_read_b64_tr_b16 a[174:175], v241 offset:12872
    ds_read_b64_tr_b16 a[176:177], v248 offset:10368
    v_mfma_f32_16x16x32_bf16 v[168:171], a[44:47], v[84:87], v[168:171]
    ds_read_b64_tr_b16 a[178:179], v248 offset:12928
    v_mfma_f32_16x16x32_bf16 v[172:175], a[48:51], v[84:87], v[172:175]
    v_mfma_f32_16x16x32_bf16 v[176:179], a[52:55], v[84:87], v[176:179]
    v_mfma_f32_16x16x32_bf16 v[180:183], a[56:59], v[84:87], v[180:183]
    s_waitcnt vmcnt(6) lgkmcnt(5)
    v_mfma_f32_16x16x32_bf16 v[184:187], a[60:63], v[96:99], v[184:187]
    buffer_load_dwordx4 v[128:131], v19, s[32:35], s52 offen sc1
    buffer_load_dwordx4 v[124:127], v18, s[32:35], s52 offen sc1
    v_mfma_f32_16x16x32_bf16 v[188:191], a[64:67], v[96:99], v[188:191]
    s_add_u32 s52, s52, 4096
    ds_read_b64_tr_b16 a[180:181], v241 offset:15360
    v_mfma_f32_16x16x32_bf16 v[192:195], a[68:71], v[96:99], v[192:195]
    ds_read_b64_tr_b16 a[182:183], v241 offset:17920
    ds_read_b64_tr_b16 a[184:185], v241 offset:15368
    v_mfma_f32_16x16x32_bf16 v[196:199], a[72:75], v[96:99], v[196:199]
    ds_read_b64_tr_b16 a[186:187], v241 offset:17928
    ds_read_b64_tr_b16 a[188:189], v241 offset:15424
    v_mfma_f32_16x16x32_bf16 v[200:203], a[76:79], v[96:99], v[200:203]
    ds_read_b64_tr_b16 a[190:191], v241 offset:17984
    ds_read_b64_tr_b16 a[192:193], v241 offset:15432
    v_mfma_f32_16x16x32_bf16 v[164:167], a[60:63], v[92:95], v[164:167]
    ds_read_b64_tr_b16 a[194:195], v241 offset:17992
    ds_read_b64_tr_b16 a[196:197], v248 offset:15488
    v_mfma_f32_16x16x32_bf16 v[168:171], a[64:67], v[92:95], v[168:171]
    ds_read_b64_tr_b16 a[198:199], v248 offset:18048
    v_mfma_f32_16x16x32_bf16 v[172:175], a[68:71], v[92:95], v[172:175]
    v_mfma_f32_16x16x32_bf16 v[176:179], a[72:75], v[92:95], v[176:179]
    v_mfma_f32_16x16x32_bf16 v[180:183], a[76:79], v[92:95], v[180:183]
    s_waitcnt vmcnt(6) lgkmcnt(5)
    v_mfma_f32_16x16x32_bf16 v[184:187], a[80:83], v[104:107], v[184:187]
    buffer_load_dwordx4 v[136:139], v19, s[32:35], s52 offen sc1
    buffer_load_dwordx4 v[132:135], v18, s[32:35], s52 offen sc1
    v_mfma_f32_16x16x32_bf16 v[188:191], a[84:87], v[104:107], v[188:191]
    s_add_u32 s52, s52, 4096
    ds_read_b64_tr_b16 a[200:201], v241 offset:20480
    v_mfma_f32_16x16x32_bf16 v[192:195], a[88:91], v[104:107], v[192:195]
    ds_read_b64_tr_b16 a[202:203], v241 offset:23040
    ds_read_b64_tr_b16 a[204:205], v241 offset:20488
    v_mfma_f32_16x16x32_bf16 v[196:199], a[92:95], v[104:107], v[196:199]
    ds_read_b64_tr_b16 a[206:207], v241 offset:23048
    ds_read_b64_tr_b16 a[208:209], v241 offset:20544
    v_mfma_f32_16x16x32_bf16 v[200:203], a[96:99], v[104:107], v[200:203]
    ds_read_b64_tr_b16 a[210:211], v241 offset:23104
    ds_read_b64_tr_b16 a[212:213], v241 offset:20552
    v_mfma_f32_16x16x32_bf16 v[164:167], a[80:83], v[100:103], v[164:167]
    ds_read_b64_tr_b16 a[214:215], v241 offset:23112
    ds_read_b64_tr_b16 a[216:217], v248 offset:20608
    v_mfma_f32_16x16x32_bf16 v[168:171], a[84:87], v[100:103], v[168:171]
    ds_read_b64_tr_b16 a[218:219], v248 offset:23168
    v_mfma_f32_16x16x32_bf16 v[172:175], a[88:91], v[100:103], v[172:175]
    v_mfma_f32_16x16x32_bf16 v[176:179], a[92:95], v[100:103], v[176:179]
    v_mfma_f32_16x16x32_bf16 v[180:183], a[96:99], v[100:103], v[180:183]
    s_waitcnt vmcnt(6) lgkmcnt(5)
    v_mfma_f32_16x16x32_bf16 v[184:187], a[100:103], v[112:115], v[184:187]
    buffer_load_dwordx4 v[144:147], v19, s[32:35], s52 offen sc1
    buffer_load_dwordx4 v[140:143], v18, s[32:35], s52 offen sc1
    v_mfma_f32_16x16x32_bf16 v[188:191], a[104:107], v[112:115], v[188:191]
    s_add_u32 s52, s52, 4096
    ds_read_b64_tr_b16 a[220:221], v241 offset:25600
    v_mfma_f32_16x16x32_bf16 v[192:195], a[108:111], v[112:115], v[192:195]
    ds_read_b64_tr_b16 a[222:223], v241 offset:28160
    ds_read_b64_tr_b16 a[224:225], v241 offset:25608
    v_mfma_f32_16x16x32_bf16 v[196:199], a[112:115], v[112:115], v[196:199]
    ds_read_b64_tr_b16 a[226:227], v241 offset:28168
    ds_read_b64_tr_b16 a[228:229], v241 offset:25664
    v_mfma_f32_16x16x32_bf16 v[200:203], a[116:119], v[112:115], v[200:203]
    ds_read_b64_tr_b16 a[230:231], v241 offset:28224
    ds_read_b64_tr_b16 a[232:233], v241 offset:25672
    v_mfma_f32_16x16x32_bf16 v[164:167], a[100:103], v[108:111], v[164:167]
    ds_read_b64_tr_b16 a[234:235], v241 offset:28232
    ds_read_b64_tr_b16 a[236:237], v248 offset:25728
    v_mfma_f32_16x16x32_bf16 v[168:171], a[104:107], v[108:111], v[168:171]
    ds_read_b64_tr_b16 a[238:239], v248 offset:28288
    v_mfma_f32_16x16x32_bf16 v[172:175], a[108:111], v[108:111], v[172:175]
    v_mfma_f32_16x16x32_bf16 v[176:179], a[112:115], v[108:111], v[176:179]
    v_mfma_f32_16x16x32_bf16 v[180:183], a[116:119], v[108:111], v[180:183]
    s_waitcnt vmcnt(6) lgkmcnt(0)
    v_mfma_f32_16x16x32_bf16 v[184:187], a[120:123], v[120:123], v[184:187]
    buffer_load_dwordx4 v[152:155], v19, s[32:35], s52 offen sc1
    buffer_load_dwordx4 v[148:151], v18, s[32:35], s52 offen sc1
    v_mfma_f32_16x16x32_bf16 v[188:191], a[124:127], v[120:123], v[188:191]
    s_add_u32 s52, s52, 4096
    v_mfma_f32_16x16x32_bf16 v[192:195], a[128:131], v[120:123], v[192:195]
    v_mfma_f32_16x16x32_bf16 v[196:199], a[132:135], v[120:123], v[196:199]
    v_mfma_f32_16x16x32_bf16 v[200:203], a[136:139], v[120:123], v[200:203]
    v_mfma_f32_16x16x32_bf16 v[164:167], a[120:123], v[116:119], v[164:167]
    v_mfma_f32_16x16x32_bf16 v[168:171], a[124:127], v[116:119], v[168:171]
    v_mfma_f32_16x16x32_bf16 v[172:175], a[128:131], v[116:119], v[172:175]
    v_mfma_f32_16x16x32_bf16 v[176:179], a[132:135], v[116:119], v[176:179]
    v_mfma_f32_16x16x32_bf16 v[180:183], a[136:139], v[116:119], v[180:183]
    s_waitcnt vmcnt(6) lgkmcnt(0)
    v_mfma_f32_16x16x32_bf16 v[184:187], a[140:143], v[128:131], v[184:187]
    buffer_load_dwordx4 v[160:163], v19, s[32:35], s52 offen sc1
    buffer_load_dwordx4 v[156:159], v18, s[32:35], s52 offen sc1
    v_mfma_f32_16x16x32_bf16 v[188:191], a[144:147], v[128:131], v[188:191]
    s_add_u32 s52, s52, 4096
    v_mfma_f32_16x16x32_bf16 v[192:195], a[148:151], v[128:131], v[192:195]
    v_mfma_f32_16x16x32_bf16 v[196:199], a[152:155], v[128:131], v[196:199]
    v_mfma_f32_16x16x32_bf16 v[200:203], a[156:159], v[128:131], v[200:203]
    v_mfma_f32_16x16x32_bf16 v[164:167], a[140:143], v[124:127], v[164:167]
    v_mfma_f32_16x16x32_bf16 v[168:171], a[144:147], v[124:127], v[168:171]
    v_mfma_f32_16x16x32_bf16 v[172:175], a[148:151], v[124:127], v[172:175]
    v_mfma_f32_16x16x32_bf16 v[176:179], a[152:155], v[124:127], v[176:179]
    v_mfma_f32_16x16x32_bf16 v[180:183], a[156:159], v[124:127], v[180:183]
    s_waitcnt vmcnt(6) lgkmcnt(0)
    v_mfma_f32_16x16x32_bf16 v[184:187], a[160:163], v[136:139], v[184:187]
    v_mfma_f32_16x16x32_bf16 v[188:191], a[164:167], v[136:139], v[188:191]
    v_mfma_f32_16x16x32_bf16 v[192:195], a[168:171], v[136:139], v[192:195]
    v_mfma_f32_16x16x32_bf16 v[196:199], a[172:175], v[136:139], v[196:199]
    v_mfma_f32_16x16x32_bf16 v[200:203], a[176:179], v[136:139], v[200:203]
    v_mfma_f32_16x16x32_bf16 v[164:167], a[160:163], v[132:135], v[164:167]
    v_mfma_f32_16x16x32_bf16 v[168:171], a[164:167], v[132:135], v[168:171]
    v_mfma_f32_16x16x32_bf16 v[172:175], a[168:171], v[132:135], v[172:175]
    v_mfma_f32_16x16x32_bf16 v[176:179], a[172:175], v[132:135], v[176:179]
    v_mfma_f32_16x16x32_bf16 v[180:183], a[176:179], v[132:135], v[180:183]
    s_waitcnt vmcnt(4)
    v_mfma_f32_16x16x32_bf16 v[184:187], a[180:183], v[144:147], v[184:187]
    v_mfma_f32_16x16x32_bf16 v[188:191], a[184:187], v[144:147], v[188:191]
    v_mfma_f32_16x16x32_bf16 v[192:195], a[188:191], v[144:147], v[192:195]
    v_mfma_f32_16x16x32_bf16 v[196:199], a[192:195], v[144:147], v[196:199]
    v_mfma_f32_16x16x32_bf16 v[200:203], a[196:199], v[144:147], v[200:203]
    s_waitcnt vmcnt(2)
    v_mfma_f32_16x16x32_bf16 v[184:187], a[200:203], v[152:155], v[184:187]
    v_mfma_f32_16x16x32_bf16 v[188:191], a[204:207], v[152:155], v[188:191]
    v_mfma_f32_16x16x32_bf16 v[192:195], a[208:211], v[152:155], v[192:195]
    v_mfma_f32_16x16x32_bf16 v[196:199], a[212:215], v[152:155], v[196:199]
    v_mfma_f32_16x16x32_bf16 v[200:203], a[216:219], v[152:155], v[200:203]
    s_waitcnt vmcnt(0)
    v_mfma_f32_16x16x32_bf16 v[184:187], a[220:223], v[160:163], v[184:187]
    v_mfma_f32_16x16x32_bf16 v[188:191], a[224:227], v[160:163], v[188:191]
    v_mfma_f32_16x16x32_bf16 v[192:195], a[228:231], v[160:163], v[192:195]
    v_mfma_f32_16x16x32_bf16 v[196:199], a[232:235], v[160:163], v[196:199]
    v_mfma_f32_16x16x32_bf16 v[200:203], a[236:239], v[160:163], v[200:203]
    v_mfma_f32_16x16x32_bf16 v[164:167], a[180:183], v[140:143], v[164:167]
    v_mfma_f32_16x16x32_bf16 v[168:171], a[184:187], v[140:143], v[168:171]
    v_mfma_f32_16x16x32_bf16 v[172:175], a[188:191], v[140:143], v[172:175]
    v_mfma_f32_16x16x32_bf16 v[176:179], a[192:195], v[140:143], v[176:179]
    v_mfma_f32_16x16x32_bf16 v[180:183], a[196:199], v[140:143], v[180:183]
    v_mfma_f32_16x16x32_bf16 v[164:167], a[200:203], v[148:151], v[164:167]
    v_mfma_f32_16x16x32_bf16 v[168:171], a[204:207], v[148:151], v[168:171]
    ds_write_b128 v6, v[184:187] offset:0
    v_mfma_f32_16x16x32_bf16 v[172:175], a[208:211], v[148:151], v[172:175]
    v_mfma_f32_16x16x32_bf16 v[176:179], a[212:215], v[148:151], v[176:179]
    ds_write_b128 v6, v[188:191] offset:1024
    v_mfma_f32_16x16x32_bf16 v[180:183], a[216:219], v[148:151], v[180:183]
    v_mfma_f32_16x16x32_bf16 v[164:167], a[220:223], v[156:159], v[164:167]
    ds_write_b128 v6, v[192:195] offset:2048
    v_mfma_f32_16x16x32_bf16 v[168:171], a[224:227], v[156:159], v[168:171]
    v_mfma_f32_16x16x32_bf16 v[172:175], a[228:231], v[156:159], v[172:175]
    ds_write_b128 v6, v[196:199] offset:3072
    v_mfma_f32_16x16x32_bf16 v[176:179], a[232:235], v[156:159], v[176:179]
    v_mfma_f32_16x16x32_bf16 v[180:183], a[236:239], v[156:159], v[180:183]
    ds_write_b128 v6, v[200:203] offset:4096
    s_waitcnt lgkmcnt(0)
    s_barrier
    ds_read_b128 v[184:187], v7 offset:0
    ds_read_b128 v[188:191], v7 offset:1024
    ds_read_b128 v[192:195], v7 offset:2048
    ds_read_b128 v[196:199], v7 offset:3072
    ds_read_b128 v[200:203], v7 offset:4096
    s_waitcnt lgkmcnt(0)
    v_pk_add_f32 v[164:165], v[164:165], v[184:185]
    v_pk_add_f32 v[166:167], v[166:167], v[186:187]
    v_pk_add_f32 v[168:169], v[168:169], v[188:189]
    v_pk_add_f32 v[170:171], v[170:171], v[190:191]
    v_pk_add_f32 v[172:173], v[172:173], v[192:193]
    v_pk_add_f32 v[174:175], v[174:175], v[194:195]
    v_pk_add_f32 v[176:177], v[176:177], v[196:197]
    v_pk_add_f32 v[178:179], v[178:179], v[198:199]
    v_pk_add_f32 v[180:181], v[180:181], v[200:201]
    v_pk_add_f32 v[182:183], v[182:183], v[202:203]
    v_cvt_pk_bf16_f32 v36, v164, v165
    v_cvt_pk_bf16_f32 v37, v166, v167
    v_cvt_pk_bf16_f32 v38, v168, v169
    v_cvt_pk_bf16_f32 v39, v170, v171
    v_cvt_pk_bf16_f32 v40, v172, v173
    v_cvt_pk_bf16_f32 v41, v174, v175
    v_cvt_pk_bf16_f32 v42, v176, v177
    v_cvt_pk_bf16_f32 v43, v178, v179
    v_cvt_pk_bf16_f32 v44, v180, v181
    v_cvt_pk_bf16_f32 v45, v182, v183
    buffer_store_dwordx4 v[36:39], v16, s[28:31], s54 offen
    buffer_store_dwordx4 v[40:43], v16, s[28:31], s54 offen offset:64
    buffer_store_dwordx2 v[44:45], v17, s[28:31], s54 offen offset:128
L_end:
    s_endpgm
.section .rodata,"a"
.p2align 6
.amdhsa_kernel sequential_preLN__spectral_fnet__mixer_gmlp__prompt_kernel
  .amdhsa_next_free_vgpr 512
  .amdhsa_next_free_sgpr 102
  .amdhsa_accum_offset 256
  .amdhsa_group_segment_fixed_size 0
  .amdhsa_kernarg_size 104
  .amdhsa_user_sgpr_count 2
  .amdhsa_user_sgpr_kernarg_segment_ptr 1
  .amdhsa_system_sgpr_workgroup_id_x 1
.end_amdhsa_kernel
```
